```python
import torch

def _softmax(x, axis=-1):
    return torch.softmax(x, dim=axis)
def _gelu(x):
    return torch.nn.functional.gelu(x, approximate="tanh")
def _silu(x):
    return torch.nn.functional.silu(x)
def _sigmoid(x):
    return torch.sigmoid(x)
def _layernorm(x, axis=-1, eps=1e-5):
    m = x.mean(dim=axis, keepdim=True)
    v = x.var(dim=axis, keepdim=True, unbiased=False)
    return (x - m) / torch.sqrt(v + eps)
def _scatter_add(tgt, idx, src, axis=0):
    return tgt.clone().index_add_(axis, idx, src)
def _segment_sum(src, seg, n):
    out = torch.zeros((n,) + src.shape[1:], dtype=src.dtype)
    return out.index_add_(0, seg, src)
def _pad(x, pw):
    flat = tuple(v for pair in reversed(pw) for v in pair)
    return torch.nn.functional.pad(x, flat)

kernel_name = 'interleave_layers__softmax_full_mha__dense_activation_relu__prompt'

def setup_inputs():

    _w = (lambda a: (lambda t: t.to(torch.bfloat16) if t.is_floating_point() else t)(torch.as_tensor(a)))
    def _A_setup():
        B, S, D = 1, 2048, 1024
        return {
            "x": _w((lambda *s: torch.randn(*s, dtype=torch.bfloat16) * 0.05)(B, S, D)),
            "wqkv": _w((lambda *s: torch.randn(*s, dtype=torch.bfloat16) * 0.05)(D, 3 * D)),
            "wo": _w((lambda *s: torch.randn(*s, dtype=torch.bfloat16) * 0.05)(D, D)),
        }
    _A_in = _A_setup()

    def _B_setup():
        B, S, D, Dff = 1, 2048, 1024, 3584
        return {
            "x": _w((lambda *s: torch.randn(*s, dtype=torch.bfloat16) * 0.05)(B, S, D)),
            "w1": _w((lambda *s: torch.randn(*s, dtype=torch.bfloat16) * 0.05)(D, Dff)),
            "w2": _w((lambda *s: torch.randn(*s, dtype=torch.bfloat16) * 0.05)(Dff, D)),
        }
    _B_in = _B_setup()

    return {
        "A_x": _A_in["x"],
        "A_wqkv": _A_in["wqkv"],
        "A_wo": _A_in["wo"],
        "B_x": _B_in["x"],
        "B_w1": _B_in["w1"],
        "B_w2": _B_in["w2"],
    }

def reference(A_x, A_wqkv, A_wo, B_x, B_w1, B_w2):
    def _A_ref(x, wqkv, wo):
        B, S, D = x.shape
        H = 32; Dh = D // H
        qkv = (lambda x, *d: x.permute(*d))((x @ wqkv).reshape(B, S, 3, H, Dh), 2, 0, 3, 1, 4)
        q, k, v = qkv[0], qkv[1], qkv[2]
        scale = Dh ** -0.5
        scores = torch.einsum("bhqd,bhkd->bhqk", q, k) * scale
        p = _softmax(scores, axis=-1)
        o = torch.einsum("bhqk,bhkd->bhqd", p, v)
        return (lambda x, *d: x.permute(*d))(o, 0, 2, 1, 3).reshape(B, S, D) @ wo

    def _B_ref(x, w1, w2):
        h = torch.einsum("bsd,df->bsf", x, w1)
        zero = torch.zeros_like(h)
        h = torch.maximum(h, zero)
        return torch.einsum("bsf,fd->bsd", h, w2)

    x = A_x
    x = x + _A_ref(_layernorm(x, axis=-1), A_wqkv, A_wo)
    x = x + _B_ref(_layernorm(x, axis=-1), B_w1, B_w2)
    x = x + _A_ref(_layernorm(x, axis=-1), A_wqkv, A_wo)
    x = x + _B_ref(_layernorm(x, axis=-1), B_w1, B_w2)
    return x
```

```asm
; @launch grid=(256,1,1) block=(512,1,1) lds=163840
.amdgcn_target "amdgcn-amd-amdhsa--gfx950"
.text
.globl interleave_layers__softmax_full_mha__dense_activation_relu__prompt_kernel
.p2align 8
.type interleave_layers__softmax_full_mha__dense_activation_relu__prompt_kernel,@function
interleave_layers__softmax_full_mha__dense_activation_relu__prompt_kernel:
    s_cmp_ge_u32 s2, 256
    s_cbranch_scc1 L_end
    s_load_dwordx2 s[4:5], s[0:1], 64
    s_load_dwordx2 s[52:53], s[0:1], 0
    s_load_dwordx4 s[80:83], s[0:1], 8
    s_load_dwordx4 s[84:87], s[0:1], 32
    s_load_dwordx2 s[16:17], s[0:1], 48
    s_and_b32 s24, s2, 7
    s_lshr_b32 s25, s2, 3
    s_and_b32 s20, s24, 1
    s_lshl_b32 s20, s20, 3
    s_and_b32 s26, s25, 7
    s_add_u32 s20, s20, s26
    s_lshr_b32 s21, s24, 2
    s_lshl_b32 s21, s21, 2
    s_lshr_b32 s26, s25, 3
    s_add_u32 s21, s21, s26
    s_lshl_b32 s21, s21, 1
    s_bfe_u32 s26, s24, 0x10001
    s_add_u32 s21, s21, s26
    v_lshrrev_b32 v3, 6, v0
    v_and_b32 v1, 63, v0
    v_lshlrev_b32 v2, 4, v1
    v_readfirstlane_b32 s22, v3
    s_mov_b32 s23, 0
    s_mul_i32 s50, s21, 7
    s_and_b32 s27, s21, 1
    s_add_u32 s51, s50, s27
    s_cmp_eq_u32 s27, 0
    s_cselect_b32 s27, 6, 0
    s_add_u32 s50, s50, s27
    v_lshrrev_b32 v4, 3, v1
    v_lshlrev_b32 v4, 11, v4
    v_and_b32 v5, 7, v1
    v_lshlrev_b32 v5, 4, v5
    s_lshl_b32 s27, s21, 7
    v_add3_u32 v232, v4, v5, s27
    v_bfe_u32 v4, v1, 4, 1
    v_lshlrev_b32 v4, 6, v4
    v_and_b32 v5, 32, v1
    v_xor_b32 v4, v4, v5
    v_xor_b32 v233, v4, v2
    s_and_b32 s88, s22, 1
    s_bfe_u32 s89, s22, 0x10001
    s_and_b32 s27, s22, 3
    s_lshl_b32 s3, s20, 2
    s_add_u32 s3, s3, s27
    s_lshl_b32 s6, s20, 1
    s_add_u32 s6, s6, s88
    s_lshl_b32 s7, s21, 1
    s_add_u32 s7, s7, s89
    s_lshl_b32 s27, s88, 5
    v_xor_b32 v234, s27, v233
    s_waitcnt lgkmcnt(0)
    s_load_dword s79, s[4:5], 0
    s_mov_b32 s8, s4
    s_mov_b32 s9, s5
    s_mov_b32 s10, 0x2000000
    s_mov_b32 s11, 0x20000
    s_mov_b32 s18, 0x400000
    s_mov_b32 s19, 0x20000
    s_mov_b32 s54, 0x400000
    s_mov_b32 s55, 0x20000
    s_mov_b32 s12, s80
    s_mov_b32 s13, s81
    s_mov_b32 s14, 0x600000
    s_mov_b32 s15, 0x20000
    v_mov_b32 v14, 0
    v_mov_b32 v15, 0
    v_mov_b32 v16, 0
    v_mov_b32 v17, 0
    v_mov_b32 v18, 0
    v_mov_b32 v19, 0
    v_mov_b32 v20, 0
    v_mov_b32 v192, 0
    v_mov_b32 v193, 0
    v_mov_b32 v194, 0
    v_mov_b32 v195, 0
    v_mov_b32 v196, 0
    v_mov_b32 v197, 0
    v_mov_b32 v198, 0
    s_mov_b32 s64, s82
    s_mov_b32 s65, s83
    s_mov_b32 s66, 0x200000
    s_mov_b32 s67, 0x20000
    s_mov_b32 s68, s86
    s_mov_b32 s69, s87
    s_mov_b32 s70, 0x700000
    s_mov_b32 s71, 0x20000
    s_mov_b32 s56, s84
    s_mov_b32 s57, s85
    s_mov_b32 s58, 0x700000
    s_mov_b32 s59, 0x20000
    s_add_u32 s72, s4, 0x1c00000
    s_addc_u32 s73, s5, 0
    s_mov_b32 s75, 0x20000
    s_and_b32 s27, s21, 7
    s_cmp_eq_u32 s27, 3
    s_cselect_b32 s74, 0x300000, 0
L_layer:
    s_lshl_b32 s27, s3, 16
    s_cmp_eq_u32 s23, 0
    s_cbranch_scc0 L_qkv_x1
    s_mov_b32 s60, 128
    v_lshrrev_b32 v4, 3, v1
    v_lshlrev_b32 v4, 11, v4
    v_and_b32 v5, 7, v1
    v_lshrrev_b32 v6, 4, v1
    v_xor_b32 v5, v5, v6
    v_lshlrev_b32 v5, 4, v5
    v_add3_u32 v10, v4, v5, s27
    v_xor_b32 v11, 64, v10
    v_add_u32 v12, 30720, v10
    v_add_u32 v13, 46080, v11
    v_add_u32 v11, 15360, v11
    s_branch L_qkv_x2
L_qkv_x1:
    s_mov_b32 s52, s16
    s_mov_b32 s53, s17
    s_mov_b32 s54, 0x400000
    s_mov_b32 s60, 4096
    v_add_u32 v10, s27, v2
    v_add_u32 v11, s27, v2
    v_add_u32 v12, s27, v2
    v_add_u32 v13, s27, v2
L_qkv_x2:
    s_cmp_ge_u32 s22, 4
    s_cbranch_scc0 L_qkv_cons
    s_cmp_eq_u32 s23, 0
    s_cbranch_scc0 L_qkv_p2
    s_sub_u32 s26, s22, 4
    s_lshl_b32 s24, s20, 2
    s_add_u32 s24, s24, s26
    s_lshl_b32 s38, s26, 12
    s_lshl_b32 s39, s26, 11
    s_lshl_b32 s40, s26, 10
    s_mov_b32 s12, s80
    s_mov_b32 s13, s81
    s_mov_b32 s14, 0x600000
    s_mov_b32 s15, 0x20000
    s_lshl_b32 s42, s21, 7
    s_add_u32 s43, s42, 2048
    s_add_u32 s44, s42, 4096
    v_lshrrev_b32 v4, 3, v1
    v_and_b32 v5, 0x70, v233
    v_xor_b32 v6, 32, v5
    s_mov_b32 s28, 6144
    v_mul_lo_u32 v4, v4, s28
    v_add_u32 v5, v4, v5
    v_add_u32 v6, v4, v6
    s_mul_i32 s29, s26, 98304
    s_add_u32 s27, s29, s42
    v_add_u32 v14, s27, v5
    s_add_u32 s27, s29, s42
    s_add_u32 s27, s27, 49152
    v_add_u32 v15, s27, v6
    s_add_u32 s27, s29, s43
    v_add_u32 v16, s27, v5
    s_add_u32 s27, s29, s43
    s_add_u32 s27, s27, 49152
    v_add_u32 v17, s27, v6
    s_add_u32 s27, s29, s44
    v_add_u32 v18, s27, v5
    s_add_u32 s27, s29, s44
    s_add_u32 s27, s27, 49152
    v_add_u32 v19, s27, v6
    s_mov_b32 s61, 393216
    s_and_b32 s27, s20, 14
    s_mul_i32 s36, s27, s61
    s_mov_b32 s47, -1
    s_lshl_b32 s63, s61, 4
    s_mov_b32 s37, 0
    s_add_u32 s33, s37, s39
    s_add_u32 m0, s33, 65536
    s_nop 0
    buffer_load_dwordx4 v14, s[12:15], s36 offen sc1 lds
    s_add_u32 m0, s33, 66560
    s_nop 0
    buffer_load_dwordx4 v15, s[12:15], s36 offen sc1 lds
    s_add_u32 m0, s33, 73728
    s_nop 0
    buffer_load_dwordx4 v16, s[12:15], s36 offen sc1 lds
    s_add_u32 m0, s33, 74752
    s_nop 0
    buffer_load_dwordx4 v17, s[12:15], s36 offen sc1 lds
    s_add_u32 m0, s33, 81920
    s_nop 0
    buffer_load_dwordx4 v18, s[12:15], s36 offen sc1 lds
    s_add_u32 m0, s33, 82944
    s_nop 0
    buffer_load_dwordx4 v19, s[12:15], s36 offen sc1 lds
    s_add_u32 s36, s36, s61
    s_cmp_eq_u32 s36, s63
    s_cselect_b32 s36, 0, s36
    s_cmp_eq_u32 s36, s47
    s_cselect_b32 s27, s61, 0
    s_add_u32 s36, s36, s27
    s_add_u32 s37, s37, 24576
    s_cmp_eq_u32 s37, 73728
    s_cselect_b32 s37, 0, s37
    s_add_u32 s33, s37, s39
    s_add_u32 m0, s33, 65536
    s_nop 0
    buffer_load_dwordx4 v14, s[12:15], s36 offen sc1 lds
    s_add_u32 m0, s33, 66560
    s_nop 0
    buffer_load_dwordx4 v15, s[12:15], s36 offen sc1 lds
    s_add_u32 m0, s33, 73728
    s_nop 0
    buffer_load_dwordx4 v16, s[12:15], s36 offen sc1 lds
    s_add_u32 m0, s33, 74752
    s_nop 0
    buffer_load_dwordx4 v17, s[12:15], s36 offen sc1 lds
    s_add_u32 m0, s33, 81920
    s_nop 0
    buffer_load_dwordx4 v18, s[12:15], s36 offen sc1 lds
    s_add_u32 m0, s33, 82944
    s_nop 0
    buffer_load_dwordx4 v19, s[12:15], s36 offen sc1 lds
    s_add_u32 s36, s36, s61
    s_cmp_eq_u32 s36, s63
    s_cselect_b32 s36, 0, s36
    s_cmp_eq_u32 s36, s47
    s_cselect_b32 s27, s61, 0
    s_add_u32 s36, s36, s27
    s_add_u32 s37, s37, 24576
    s_cmp_eq_u32 s37, 73728
    s_cselect_b32 s37, 0, s37
L_qkv_p2:
    s_lshl_b32 s62, s60, 4
    s_waitcnt lgkmcnt(0)
    s_lshl_b32 s78, s23, 4
    s_add_u32 s78, s78, s79
    s_add_u32 s78, s78, 32
    s_cmp_lt_u32 s26, 3
    s_cselect_b32 s32, 1, 0
    s_cmp_eq_u32 s23, 0
    s_cselect_b32 s32, s32, 0
    s_mul_i32 s34, s32, 63
    s_and_b32 s46, s20, 1
    s_lshl_b32 s34, s34, s46
    s_mov_b32 s41, 0
    s_cmp_eq_u32 s23, 0
    s_cbranch_scc0 L_qp_own
    s_waitcnt vmcnt(6)
    s_barrier
    s_and_b32 s35, s20, 14
    s_add_u32 s35, s35, 2
    s_and_b32 s35, s35, 15
    s_mul_i32 s35, s35, s60
    s_mov_b32 s43, -1
    s_mov_b32 s45, 32768
    s_add_u32 m0, s45, s38
    s_add_u32 s45, s45, 16384
    buffer_load_dwordx4 v10, s[52:55], s35 offen offset:0 sc1 lds
    buffer_load_dwordx4 v11, s[52:55], s35 offen offset:1024 sc1 lds
    buffer_load_dwordx4 v12, s[52:55], s35 offen offset:2048 sc1 lds
    buffer_load_dwordx4 v13, s[52:55], s35 offen offset:3072 sc1 lds
    s_and_b32 s45, s45, 0xffff
    s_add_u32 s35, s35, s60
    s_cmp_eq_u32 s35, s62
    s_cselect_b32 s35, 0, s35
    s_cmp_eq_u32 s35, s43
    s_cselect_b32 s27, s60, 0
    s_add_u32 s35, s35, s27
    s_branch L_qp_go
L_qp_own:
    s_mul_i32 s43, s21, s60
    s_cmp_eq_u32 s43, 0
    s_cselect_b32 s35, s60, 0
    s_mov_b32 s45, 16384
    s_lshr_b32 s29, s24, 1
    s_lshl_b32 s25, s29, 9
    s_add_u32 s25, s25, 0x1a00000
    s_waitcnt vmcnt(6)
    s_barrier
    v_and_b32 v8, 31, v1
    v_lshlrev_b32 v8, 4, v8
    buffer_load_dword v9, v8, s[8:11], s25 offen sc1
    s_add_u32 s33, s37, s39
    s_add_u32 m0, s33, 65536
    s_nop 0
    buffer_load_dwordx4 v14, s[12:15], s36 offen sc1 lds
    s_add_u32 m0, s33, 66560
    s_nop 0
    buffer_load_dwordx4 v15, s[12:15], s36 offen sc1 lds
    s_add_u32 m0, s33, 73728
    s_nop 0
    buffer_load_dwordx4 v16, s[12:15], s36 offen sc1 lds
    s_add_u32 m0, s33, 74752
    s_nop 0
    buffer_load_dwordx4 v17, s[12:15], s36 offen sc1 lds
    s_add_u32 m0, s33, 81920
    s_nop 0
    buffer_load_dwordx4 v18, s[12:15], s36 offen sc1 lds
    s_add_u32 m0, s33, 82944
    s_nop 0
    buffer_load_dwordx4 v19, s[12:15], s36 offen sc1 lds
    s_add_u32 s36, s36, s61
    s_cmp_eq_u32 s36, s63
    s_cselect_b32 s36, 0, s36
    s_cmp_eq_u32 s36, s47
    s_cselect_b32 s27, s61, 0
    s_add_u32 s36, s36, s27
    s_add_u32 s37, s37, 24576
    s_cmp_eq_u32 s37, 73728
    s_cselect_b32 s37, 0, s37
    s_waitcnt vmcnt(6)
    v_cmp_ne_u32 vcc, s78, v9
    s_cbranch_vccz L_qp_rdy
    v_and_b32 v8, 31, v1
    v_lshlrev_b32 v8, 4, v8
    s_mov_b32 s27, 0
L_poll_3:
    buffer_load_dword v9, v8, s[8:11], s25 offen sc1
    s_add_u32 s27, s27, 1
    s_waitcnt vmcnt(0)
    v_cmp_ne_u32 vcc, s78, v9
    s_cbranch_vccz L_pd_4
    s_sleep 1
    s_cmp_lt_u32 s27, 0x40000
    s_cbranch_scc1 L_poll_3
L_pd_4:
L_qp_rdy:
    s_add_u32 m0, s45, s38
    s_add_u32 s45, s45, 16384
    buffer_load_dwordx4 v10, s[52:55], s35 offen offset:0 sc1 lds
    buffer_load_dwordx4 v11, s[52:55], s35 offen offset:1024 sc1 lds
    buffer_load_dwordx4 v12, s[52:55], s35 offen offset:2048 sc1 lds
    buffer_load_dwordx4 v13, s[52:55], s35 offen offset:3072 sc1 lds
    s_and_b32 s45, s45, 0xffff
    s_add_u32 s35, s35, s60
    s_cmp_eq_u32 s35, s62
    s_cselect_b32 s35, 0, s35
    s_cmp_eq_u32 s35, s43
    s_cselect_b32 s27, s60, 0
    s_add_u32 s35, s35, s27
    s_add_u32 m0, s45, s38
    s_add_u32 s45, s45, 16384
    buffer_load_dwordx4 v10, s[52:55], s35 offen offset:0 sc1 lds
    buffer_load_dwordx4 v11, s[52:55], s35 offen offset:1024 sc1 lds
    buffer_load_dwordx4 v12, s[52:55], s35 offen offset:2048 sc1 lds
    buffer_load_dwordx4 v13, s[52:55], s35 offen offset:3072 sc1 lds
    s_and_b32 s45, s45, 0xffff
    s_add_u32 s35, s35, s60
    s_cmp_eq_u32 s35, s62
    s_cselect_b32 s35, 0, s35
    s_cmp_eq_u32 s35, s43
    s_cselect_b32 s27, s60, 0
    s_add_u32 s35, s35, s27
    s_add_u32 m0, s45, s38
    s_add_u32 s45, s45, 16384
    buffer_load_dwordx4 v10, s[52:55], s35 offen offset:0 sc1 lds
    buffer_load_dwordx4 v11, s[52:55], s35 offen offset:1024 sc1 lds
    buffer_load_dwordx4 v12, s[52:55], s35 offen offset:2048 sc1 lds
    buffer_load_dwordx4 v13, s[52:55], s35 offen offset:3072 sc1 lds
    s_and_b32 s45, s45, 0xffff
    s_add_u32 s35, s35, s60
    s_cmp_eq_u32 s35, s62
    s_cselect_b32 s35, 0, s35
    s_cmp_eq_u32 s35, s43
    s_cselect_b32 s27, s60, 0
    s_add_u32 s35, s35, s27
    s_mov_b32 s41, 1
    s_waitcnt vmcnt(8)
    s_branch L_qp_bar
L_qp_loop:
    s_waitcnt vmcnt(14)
L_qp_bar:
    s_barrier
L_qp_go:
    s_add_u32 s33, s37, s39
    s_add_u32 m0, s33, 65536
    s_nop 0
    buffer_load_dwordx4 v14, s[12:15], s36 offen sc1 lds
    s_add_u32 m0, s33, 66560
    s_nop 0
    buffer_load_dwordx4 v15, s[12:15], s36 offen sc1 lds
    s_add_u32 m0, s33, 73728
    s_nop 0
    buffer_load_dwordx4 v16, s[12:15], s36 offen sc1 lds
    s_add_u32 m0, s33, 74752
    s_nop 0
    buffer_load_dwordx4 v17, s[12:15], s36 offen sc1 lds
    s_add_u32 m0, s33, 81920
    s_nop 0
    buffer_load_dwordx4 v18, s[12:15], s36 offen sc1 lds
    s_add_u32 m0, s33, 82944
    s_nop 0
    buffer_load_dwordx4 v19, s[12:15], s36 offen sc1 lds
    s_add_u32 s36, s36, s61
    s_cmp_eq_u32 s36, s63
    s_cselect_b32 s36, 0, s36
    s_cmp_eq_u32 s36, s47
    s_cselect_b32 s27, s61, 0
    s_add_u32 s36, s36, s27
    s_add_u32 s37, s37, 24576
    s_cmp_eq_u32 s37, 73728
    s_cselect_b32 s37, 0, s37
    s_add_u32 m0, s45, s38
    s_add_u32 s45, s45, 16384
    buffer_load_dwordx4 v10, s[52:55], s35 offen offset:0 sc1 lds
    buffer_load_dwordx4 v11, s[52:55], s35 offen offset:1024 sc1 lds
    buffer_load_dwordx4 v12, s[52:55], s35 offen offset:2048 sc1 lds
    buffer_load_dwordx4 v13, s[52:55], s35 offen offset:3072 sc1 lds
    s_and_b32 s45, s45, 0xffff
    s_add_u32 s35, s35, s60
    s_cmp_eq_u32 s35, s62
    s_cselect_b32 s35, 0, s35
    s_cmp_eq_u32 s35, s43
    s_cselect_b32 s27, s60, 0
    s_add_u32 s35, s35, s27
    s_bitcmp1_b32 s34, s41
    s_cbranch_scc1 L_qp_hook
L_qp_ret:
    s_add_u32 s41, s41, 1
    s_cmp_lt_u32 s41, 13
    s_cbranch_scc1 L_qp_loop
    s_waitcnt vmcnt(14)
    s_barrier
    v_and_b32 v7, 31, v1
    v_lshlrev_b32 v7, 4, v7
    s_lshr_b32 s29, s24, 1
    s_lshl_b32 s25, s29, 9
    s_add_u32 s25, s25, 0x1a00000
    buffer_load_dword v98, v7, s[8:11], s25 offen sc1
    s_add_u32 s33, s37, s39
    s_add_u32 m0, s33, 65536
    s_nop 0
    buffer_load_dwordx4 v14, s[12:15], s36 offen sc1 lds
    s_add_u32 m0, s33, 66560
    s_nop 0
    buffer_load_dwordx4 v15, s[12:15], s36 offen sc1 lds
    s_add_u32 m0, s33, 73728
    s_nop 0
    buffer_load_dwordx4 v16, s[12:15], s36 offen sc1 lds
    s_add_u32 m0, s33, 74752
    s_nop 0
    buffer_load_dwordx4 v17, s[12:15], s36 offen sc1 lds
    s_add_u32 m0, s33, 81920
    s_nop 0
    buffer_load_dwordx4 v18, s[12:15], s36 offen sc1 lds
    s_add_u32 m0, s33, 82944
    s_nop 0
    buffer_load_dwordx4 v19, s[12:15], s36 offen sc1 lds
    s_add_u32 s36, s36, s61
    s_cmp_eq_u32 s36, s63
    s_cselect_b32 s36, 0, s36
    s_cmp_eq_u32 s36, s47
    s_cselect_b32 s27, s61, 0
    s_add_u32 s36, s36, s27
    s_add_u32 s37, s37, 24576
    s_cmp_eq_u32 s37, 73728
    s_cselect_b32 s37, 0, s37
    s_waitcnt vmcnt(11)
    s_barrier
    s_waitcnt vmcnt(6)
    v_cmp_ne_u32 vcc, s78, v98
    s_cbranch_vccz L_dn_5
    v_and_b32 v8, 31, v1
    v_lshlrev_b32 v8, 4, v8
    s_mov_b32 s27, 0
L_poll_6:
    buffer_load_dword v9, v8, s[8:11], s25 offen sc1
    s_add_u32 s27, s27, 1
    s_waitcnt vmcnt(0)
    v_cmp_ne_u32 vcc, s78, v9
    s_cbranch_vccz L_pd_7
    s_sleep 1
    s_cmp_lt_u32 s27, 0x40000
    s_cbranch_scc1 L_poll_6
L_pd_7:
L_dn_5:
    v_lshrrev_b32 v6, 5, v1
    v_lshlrev_b32 v6, 10, v6
    v_and_b32 v7, 31, v1
    v_lshlrev_b32 v7, 4, v7
    v_add_u32 v7, v7, v6
    s_lshr_b32 s27, s24, 1
    s_lshl_b32 s27, s27, 14
    s_and_b32 s28, s24, 1
    s_lshl_b32 s28, s28, 9
    s_add_u32 s27, s27, s28
    s_add_u32 s27, s27, 0x1600000
    buffer_load_dwordx4 v[32:35], v7, s[8:11], s27 offen offset:0 sc1
    buffer_load_dwordx4 v[36:39], v7, s[8:11], s27 offen offset:2048 sc1
    s_add_u32 s27, s27, 4096
    buffer_load_dwordx4 v[40:43], v7, s[8:11], s27 offen offset:0 sc1
    buffer_load_dwordx4 v[44:47], v7, s[8:11], s27 offen offset:2048 sc1
    s_add_u32 s27, s27, 4096
    buffer_load_dwordx4 v[48:51], v7, s[8:11], s27 offen offset:0 sc1
    buffer_load_dwordx4 v[52:55], v7, s[8:11], s27 offen offset:2048 sc1
    s_add_u32 s27, s27, 4096
    buffer_load_dwordx4 v[56:59], v7, s[8:11], s27 offen offset:0 sc1
    buffer_load_dwordx4 v[60:63], v7, s[8:11], s27 offen offset:2048 sc1
    s_cmp_eq_u32 s32, 0
    s_cbranch_scc1 L_hc_8
    v_lshlrev_b32 v7, 3, v1
    s_lshl_b32 s27, s21, 15
    s_lshl_b32 s28, s26, 13
    s_add_u32 s27, s27, s28
    s_add_u32 s27, s27, 0x1800000
    s_add_u32 s28, s27, 4096
    buffer_load_dwordx2 v[100:101], v7, s[8:11], s27 offen offset:0 sc1
    buffer_load_dwordx2 v[102:103], v7, s[8:11], s27 offen offset:512 sc1
    buffer_load_dwordx2 v[104:105], v7, s[8:11], s27 offen offset:1024 sc1
    buffer_load_dwordx2 v[106:107], v7, s[8:11], s27 offen offset:1536 sc1
    buffer_load_dwordx2 v[108:109], v7, s[8:11], s27 offen offset:2048 sc1
    buffer_load_dwordx2 v[110:111], v7, s[8:11], s27 offen offset:2560 sc1
    buffer_load_dwordx2 v[112:113], v7, s[8:11], s27 offen offset:3072 sc1
    buffer_load_dwordx2 v[114:115], v7, s[8:11], s27 offen offset:3584 sc1
    buffer_load_dwordx2 v[116:117], v7, s[8:11], s28 offen offset:0 sc1
    buffer_load_dwordx2 v[118:119], v7, s[8:11], s28 offen offset:512 sc1
    buffer_load_dwordx2 v[120:121], v7, s[8:11], s28 offen offset:1024 sc1
    buffer_load_dwordx2 v[122:123], v7, s[8:11], s28 offen offset:1536 sc1
    buffer_load_dwordx2 v[124:125], v7, s[8:11], s28 offen offset:2048 sc1
    buffer_load_dwordx2 v[126:127], v7, s[8:11], s28 offen offset:2560 sc1
    buffer_load_dwordx2 v[128:129], v7, s[8:11], s28 offen offset:3072 sc1
    buffer_load_dwordx2 v[130:131], v7, s[8:11], s28 offen offset:3584 sc1
L_hc_8:
    s_waitcnt vmcnt(8)
    s_barrier
    s_waitcnt vmcnt(0)
    v_pk_add_f32 v[32:33], v[32:33], v[48:49]
    v_pk_add_f32 v[34:35], v[34:35], v[50:51]
    v_pk_add_f32 v[36:37], v[36:37], v[52:53]
    v_pk_add_f32 v[38:39], v[38:39], v[54:55]
    v_pk_add_f32 v[40:41], v[40:41], v[56:57]
    v_pk_add_f32 v[42:43], v[42:43], v[58:59]
    v_pk_add_f32 v[44:45], v[44:45], v[60:61]
    v_pk_add_f32 v[46:47], v[46:47], v[62:63]
    v_pk_add_f32 v[32:33], v[32:33], v[40:41]
    v_pk_add_f32 v[34:35], v[34:35], v[42:43]
    v_pk_add_f32 v[36:37], v[36:37], v[44:45]
    v_pk_add_f32 v[38:39], v[38:39], v[46:47]
    v_pk_add_f32 v[32:33], v[32:33], v[36:37]
    v_pk_add_f32 v[34:35], v[34:35], v[38:39]
    v_pk_add_f32 v[32:33], v[32:33], v[34:35]
    v_mov_b32 v34, v32
    v_mov_b32 v35, v33
    s_nop 1
    v_permlane32_swap_b32 v32, v34
    v_permlane32_swap_b32 v33, v35
    v_add_f32 v32, v32, v34
    v_add_f32 v33, v33, v35
    v_mul_f32 v36, 0xba800000, v32
    v_mul_f32 v38, 0x3a800000, v33
    v_fma_f32 v38, -v36, v36, v38
    v_max_f32 v38, 0, v38
    v_add_f32 v38, 0x3727c5ac, v38
    v_rsq_f32 v37, v38
    s_lshl_b32 s27, s26, 7
    s_add_u32 s27, s27, 155648
    v_and_b32 v7, 31, v1
    v_lshlrev_b32 v7, 2, v7
    v_add_u32 v7, s27, v7
    ds_write_b32 v7, v36
    ds_write_b32 v7, v37 offset:512
    s_cmp_eq_u32 s32, 0
    s_cbranch_scc1 L_he_10
    s_mov_b32 s29, 0
L_hr_11:
    v_bitop3_b32 v140, v101, v103, s78 bitop3:0x7e
    v_bitop3_b32 v141, v105, v107, s78 bitop3:0x7e
    v_bitop3_b32 v142, v109, v111, s78 bitop3:0x7e
    v_bitop3_b32 v143, v113, v115, s78 bitop3:0x7e
    v_bitop3_b32 v144, v117, v119, s78 bitop3:0x7e
    v_bitop3_b32 v145, v121, v123, s78 bitop3:0x7e
    v_bitop3_b32 v146, v125, v127, s78 bitop3:0x7e
    v_bitop3_b32 v147, v129, v131, s78 bitop3:0x7e
    v_or3_b32 v140, v140, v141, v142
    v_or3_b32 v143, v143, v144, v145
    v_or3_b32 v140, v140, v146, v147
    v_or_b32 v140, v140, v143
    v_cmp_ne_u32 vcc, 0, v140
    s_cbranch_vccz L_ho_12
    v_lshlrev_b32 v7, 3, v1
    s_lshl_b32 s27, s21, 15
    s_lshl_b32 s28, s26, 13
    s_add_u32 s27, s27, s28
    s_add_u32 s27, s27, 0x1800000
    s_add_u32 s28, s27, 4096
    buffer_load_dwordx2 v[100:101], v7, s[8:11], s27 offen offset:0 sc1
    buffer_load_dwordx2 v[102:103], v7, s[8:11], s27 offen offset:512 sc1
    buffer_load_dwordx2 v[104:105], v7, s[8:11], s27 offen offset:1024 sc1
    buffer_load_dwordx2 v[106:107], v7, s[8:11], s27 offen offset:1536 sc1
    buffer_load_dwordx2 v[108:109], v7, s[8:11], s27 offen offset:2048 sc1
    buffer_load_dwordx2 v[110:111], v7, s[8:11], s27 offen offset:2560 sc1
    buffer_load_dwordx2 v[112:113], v7, s[8:11], s27 offen offset:3072 sc1
    buffer_load_dwordx2 v[114:115], v7, s[8:11], s27 offen offset:3584 sc1
    buffer_load_dwordx2 v[116:117], v7, s[8:11], s28 offen offset:0 sc1
    buffer_load_dwordx2 v[118:119], v7, s[8:11], s28 offen offset:512 sc1
    buffer_load_dwordx2 v[120:121], v7, s[8:11], s28 offen offset:1024 sc1
    buffer_load_dwordx2 v[122:123], v7, s[8:11], s28 offen offset:1536 sc1
    buffer_load_dwordx2 v[124:125], v7, s[8:11], s28 offen offset:2048 sc1
    buffer_load_dwordx2 v[126:127], v7, s[8:11], s28 offen offset:2560 sc1
    buffer_load_dwordx2 v[128:129], v7, s[8:11], s28 offen offset:3072 sc1
    buffer_load_dwordx2 v[130:131], v7, s[8:11], s28 offen offset:3584 sc1
    s_add_u32 s29, s29, 1
    s_waitcnt vmcnt(0)
    s_cmp_lt_u32 s29, 0x40000
    s_cbranch_scc1 L_hr_11
L_ho_12:
    v_add_f32 v100, v100, v102
    v_add_f32 v100, v100, v104
    v_add_f32 v100, v100, v106
    v_add_f32 v100, v100, v108
    v_add_f32 v100, v100, v110
    v_add_f32 v100, v100, v112
    v_add_f32 v100, v100, v114
    v_add_f32 v100, v100, v116
    v_add_f32 v100, v100, v118
    v_add_f32 v100, v100, v120
    v_add_f32 v100, v100, v122
    v_add_f32 v100, v100, v124
    v_add_f32 v100, v100, v126
    v_add_f32 v100, v100, v128
    v_add_f32 v100, v100, v130
    s_lshl_b32 s27, s26, 8
    s_add_u32 s27, s27, 156672
    v_and_b32 v7, 7, v1
    v_lshlrev_b32 v7, 5, v7
    v_lshrrev_b32 v6, 3, v1
    v_lshlrev_b32 v6, 2, v6
    v_add3_u32 v7, v7, v6, s27
    ds_write_b32 v7, v100
L_he_10:
    s_waitcnt lgkmcnt(0)
    s_barrier
    s_branch L_qkv_done
L_qkv_cons:
    s_setprio 1
    s_lshl_b32 s29, s88, 13
    s_cmp_eq_u32 s23, 0
    s_cbranch_scc0 L_qkv_c1
    s_and_b32 s35, s20, 14
    s_lshl_b32 s35, s35, 7
    s_lshl_b32 s38, s22, 12
    s_add_u32 m0, s38, 0
    s_nop 0
    buffer_load_dwordx4 v10, s[52:55], s35 offen offset:0 sc1 lds
    buffer_load_dwordx4 v11, s[52:55], s35 offen offset:1024 sc1 lds
    buffer_load_dwordx4 v12, s[52:55], s35 offen offset:2048 sc1 lds
    buffer_load_dwordx4 v13, s[52:55], s35 offen offset:3072 sc1 lds
    s_add_u32 s35, s35, s60
    s_add_u32 m0, s38, 16384
    s_nop 0
    buffer_load_dwordx4 v10, s[52:55], s35 offen offset:0 sc1 lds
    buffer_load_dwordx4 v11, s[52:55], s35 offen offset:1024 sc1 lds
    buffer_load_dwordx4 v12, s[52:55], s35 offen offset:2048 sc1 lds
    buffer_load_dwordx4 v13, s[52:55], s35 offen offset:3072 sc1 lds
    v_and_b32 v4, 15, v1
    v_lshlrev_b32 v4, 11, v4
    v_lshrrev_b32 v5, 4, v1
    v_lshlrev_b32 v5, 3, v5
    v_add_u32 v4, v4, v5
    s_lshl_b32 s27, s6, 17
    s_lshl_b32 s28, s7, 6
    s_add_u32 s27, s27, s28
    buffer_load_dwordx2 v[240:241], v4, s[52:55], s27 offen offset:0
    buffer_load_dwordx2 v[242:243], v4, s[52:55], s27 offen offset:32
    s_add_u32 s27, s27, 32768
    buffer_load_dwordx2 v[244:245], v4, s[52:55], s27 offen offset:0
    buffer_load_dwordx2 v[246:247], v4, s[52:55], s27 offen offset:32
    s_add_u32 s27, s27, 32768
    buffer_load_dwordx2 v[248:249], v4, s[52:55], s27 offen offset:0
    buffer_load_dwordx2 v[250:251], v4, s[52:55], s27 offen offset:32
    s_add_u32 s27, s27, 32768
    buffer_load_dwordx2 v[252:253], v4, s[52:55], s27 offen offset:0
    buffer_load_dwordx2 v[254:255], v4, s[52:55], s27 offen offset:32
    s_lshr_b32 s27, s2, 3
    s_lshl_b32 s27, s27, 2
    s_add_u32 s27, s27, s22
    s_mul_i32 s27, s27, 49152
    s_and_b32 s28, s21, 8
    s_lshl_b32 s28, s28, 7
    s_add_u32 s27, s27, s28
    s_bitcmp1_b32 s21, 0
    s_cselect_b32 s27, s27, 0x800000
    s_add_u32 s28, s27, 4096
    v_lshrrev_b32 v8, 3, v1
    v_mul_u32_u24 v8, 6144, v8
    v_and_b32 v9, 7, v1
    v_lshlrev_b32 v9, 4, v9
    v_add_u32 v8, v8, v9
    buffer_load_dwordx4 v[224:227], v8, s[12:15], s27 offen offset:384
    buffer_load_dwordx4 v[224:227], v8, s[12:15], s27 offen offset:2432
    buffer_load_dwordx4 v[224:227], v8, s[12:15], s28 offen offset:384
    s_getpc_b64 s[28:29]
L_pc:
    s_lshr_b32 s27, s2, 3
    s_lshl_b32 s27, s27, 2
    s_add_u32 s27, s27, s22
    s_lshl_b32 s27, s27, 10
    s_min_u32 s27, s27, L_code_end-L_pc-1024
    s_add_u32 s28, s28, s27
    s_addc_u32 s29, s29, 0
    v_mov_b32 v5, s29
    v_add_co_u32 v4, vcc, s28, v2
    s_nop 1
    v_addc_co_u32 v5, vcc, 0, v5, vcc
    global_load_dwordx4 v[228:231], v[4:5], off
    s_lshl_b32 s29, s88, 13
    v_and_b32 v4, 15, v1
    v_lshrrev_b32 v5, 1, v4
    v_lshrrev_b32 v6, 4, v1
    v_xor_b32 v5, v5, v6
    v_lshlrev_b32 v5, 4, v5
    v_lshlrev_b32 v4, 7, v4
    v_add3_u32 v44, v4, v5, s29
    v_add_u32 v45, 2048, v44
    v_xor_b32 v46, 64, v44
    v_xor_b32 v47, 64, v45
    v_lshrrev_b32 v3, 4, v1
    v_bfe_u32 v4, v1, 2, 2
    v_lshlrev_b32 v8, 3, v3
    v_add_u32 v8, v8, v4
    v_lshlrev_b32 v8, 7, v8
    v_and_b32 v5, 3, v1
    v_lshlrev_b32 v5, 3, v5
    v_and_b32 v6, 1, v3
    v_lshlrev_b32 v6, 5, v6
    v_xor_b32 v5, v5, v6
    v_bfe_u32 v6, v1, 3, 1
    v_lshlrev_b32 v6, 6, v6
    v_xor_b32 v5, v5, v6
    s_lshl_b32 s27, s89, 6
    v_xor_b32 v5, s27, v5
    v_add_u32 v8, v8, v5
    v_add_u32 v48, 65536, v8
    v_xor_b32 v50, 32, v48
    v_add_u32 v49, 512, v50
    v_add_u32 v51, 512, v48
    s_branch L_qkv_c2
L_qkv_c1:
    v_add_u32 v44, s29, v2
    v_add_u32 v45, 1024, v44
    v_add_u32 v46, 2048, v44
    v_add_u32 v47, 3072, v44
    v_lshrrev_b32 v3, 4, v1
    v_bfe_u32 v4, v1, 2, 2
    v_lshlrev_b32 v8, 2, v3
    v_add_u32 v8, v8, v4
    v_lshlrev_b32 v8, 7, v8
    v_and_b32 v5, 3, v1
    v_lshlrev_b32 v5, 3, v5
    v_and_b32 v6, 1, v3
    v_lshrrev_b32 v7, 5, v1
    v_xor_b32 v6, v6, v7
    v_lshlrev_b32 v6, 5, v6
    v_xor_b32 v5, v5, v6
    v_bfe_u32 v6, v1, 3, 1
    v_lshlrev_b32 v6, 6, v6
    v_xor_b32 v5, v5, v6
    s_lshl_b32 s27, s89, 6
    v_xor_b32 v5, s27, v5
    v_add_u32 v8, v8, v5
    v_add_u32 v48, 65536, v8
    v_xor_b32 v50, 32, v48
    v_add_u32 v49, 2048, v48
    v_add_u32 v51, 2048, v50
L_qkv_c2:
    v_mov_b32 v64, 0
    v_mov_b32 v65, 0
    v_mov_b32 v66, 0
    v_mov_b32 v67, 0
    v_mov_b32 v68, 0
    v_mov_b32 v69, 0
    v_mov_b32 v70, 0
    v_mov_b32 v71, 0
    v_mov_b32 v72, 0
    v_mov_b32 v73, 0
    v_mov_b32 v74, 0
    v_mov_b32 v75, 0
    v_mov_b32 v76, 0
    v_mov_b32 v77, 0
    v_mov_b32 v78, 0
    v_mov_b32 v79, 0
    v_mov_b32 v80, 0
    v_mov_b32 v81, 0
    v_mov_b32 v82, 0
    v_mov_b32 v83, 0
    v_mov_b32 v84, 0
    v_mov_b32 v85, 0
    v_mov_b32 v86, 0
    v_mov_b32 v87, 0
    v_mov_b32 v88, 0
    v_mov_b32 v89, 0
    v_mov_b32 v90, 0
    v_mov_b32 v91, 0
    v_mov_b32 v92, 0
    v_mov_b32 v93, 0
    v_mov_b32 v94, 0
    v_mov_b32 v95, 0
    v_mov_b32 v96, 0
    v_mov_b32 v97, 0
    v_mov_b32 v98, 0
    v_mov_b32 v99, 0
    v_mov_b32 v100, 0
    v_mov_b32 v101, 0
    v_mov_b32 v102, 0
    v_mov_b32 v103, 0
    v_mov_b32 v104, 0
    v_mov_b32 v105, 0
    v_mov_b32 v106, 0
    v_mov_b32 v107, 0
    v_mov_b32 v108, 0
    v_mov_b32 v109, 0
    v_mov_b32 v110, 0
    v_mov_b32 v111, 0
    v_mov_b32 v112, 0
    v_mov_b32 v113, 0
    v_mov_b32 v114, 0
    v_mov_b32 v115, 0
    v_mov_b32 v116, 0
    v_mov_b32 v117, 0
    v_mov_b32 v118, 0
    v_mov_b32 v119, 0
    v_mov_b32 v120, 0
    v_mov_b32 v121, 0
    v_mov_b32 v122, 0
    v_mov_b32 v123, 0
    v_mov_b32 v124, 0
    v_mov_b32 v125, 0
    v_mov_b32 v126, 0
    v_mov_b32 v127, 0
    v_mov_b32 v128, 0
    v_mov_b32 v129, 0
    v_mov_b32 v130, 0
    v_mov_b32 v131, 0
    v_mov_b32 v132, 0
    v_mov_b32 v133, 0
    v_mov_b32 v134, 0
    v_mov_b32 v135, 0
    v_mov_b32 v136, 0
    v_mov_b32 v137, 0
    v_mov_b32 v138, 0
    v_mov_b32 v139, 0
    v_mov_b32 v140, 0
    v_mov_b32 v141, 0
    v_mov_b32 v142, 0
    v_mov_b32 v143, 0
    v_mov_b32 v144, 0
    v_mov_b32 v145, 0
    v_mov_b32 v146, 0
    v_mov_b32 v147, 0
    v_mov_b32 v148, 0
    v_mov_b32 v149, 0
    v_mov_b32 v150, 0
    v_mov_b32 v151, 0
    v_mov_b32 v152, 0
    v_mov_b32 v153, 0
    v_mov_b32 v154, 0
    v_mov_b32 v155, 0
    v_mov_b32 v156, 0
    v_mov_b32 v157, 0
    v_mov_b32 v158, 0
    v_mov_b32 v159, 0
    s_waitcnt lgkmcnt(0)
    s_lshl_b32 s78, s23, 4
    s_add_u32 s78, s78, s79
    s_add_u32 s78, s78, 32
    s_cmp_eq_u32 s23, 0
    s_cbranch_scc0 L_qkv_c3
    s_waitcnt vmcnt(12)
L_qkv_c3:
L_qkv_c4:
    s_mov_b32 s31, 0
    s_mov_b32 s32, 0
    s_mov_b32 s30, 0
    v_add_u32 v52, s32, v44
    v_add_u32 v53, s32, v45
    v_add_u32 v54, s32, v46
    v_add_u32 v55, s32, v47
    v_add_u32 v56, s31, v48
    v_add_u32 v57, s31, v49
    v_add_u32 v58, s31, v50
    v_add_u32 v59, s31, v51
    s_barrier
    ds_read_b128 v[160:163], v52 offset:0
    ds_read_b64_tr_b16 v[20:21], v56 offset:0
    ds_read_b64_tr_b16 v[22:23], v57 offset:0
    ds_read_b128 v[164:167], v53 offset:0
    ds_read_b128 v[168:171], v52 offset:4096
    ds_read_b128 v[172:175], v53 offset:4096
    ds_read_b64_tr_b16 v[24:25], v58 offset:0
    ds_read_b64_tr_b16 v[26:27], v59 offset:0
    ds_read_b64_tr_b16 v[28:29], v56 offset:8192
    ds_read_b64_tr_b16 v[30:31], v57 offset:8192
    ds_read_b64_tr_b16 v[32:33], v58 offset:8192
    ds_read_b64_tr_b16 v[34:35], v59 offset:8192
    ds_read_b64_tr_b16 v[36:37], v56 offset:16384
    ds_read_b64_tr_b16 v[38:39], v57 offset:16384
    ds_read_b64_tr_b16 v[40:41], v58 offset:16384
    s_waitcnt lgkmcnt(4)
    v_mfma_f32_16x16x32_bf16 v[64:67], v[20:23], v[160:163], v[64:67]
    ds_read_b64_tr_b16 v[42:43], v59 offset:16384
    v_mfma_f32_16x16x32_bf16 v[72:75], v[20:23], v[164:167], v[72:75]
    ds_read_b128 v[176:179], v54 offset:0
    v_mfma_f32_16x16x32_bf16 v[80:83], v[20:23], v[168:171], v[80:83]
    s_add_u32 s32, s32, 16384
    v_mfma_f32_16x16x32_bf16 v[88:91], v[20:23], v[172:175], v[88:91]
    ds_read_b64_tr_b16 v[20:21], v56 offset:4096
    v_mfma_f32_16x16x32_bf16 v[68:71], v[24:27], v[160:163], v[68:71]
    ds_read_b64_tr_b16 v[22:23], v57 offset:4096
    v_mfma_f32_16x16x32_bf16 v[76:79], v[24:27], v[164:167], v[76:79]
    ds_read_b128 v[180:183], v55 offset:0
    v_mfma_f32_16x16x32_bf16 v[84:87], v[24:27], v[168:171], v[84:87]
    ds_read_b128 v[184:187], v54 offset:4096
    v_mfma_f32_16x16x32_bf16 v[92:95], v[24:27], v[172:175], v[92:95]
    ds_read_b128 v[188:191], v55 offset:4096
    v_mfma_f32_16x16x32_bf16 v[96:99], v[28:31], v[160:163], v[96:99]
    ds_read_b64_tr_b16 v[24:25], v58 offset:4096
    v_mfma_f32_16x16x32_bf16 v[104:107], v[28:31], v[164:167], v[104:107]
    ds_read_b64_tr_b16 v[26:27], v59 offset:4096
    v_mfma_f32_16x16x32_bf16 v[112:115], v[28:31], v[168:171], v[112:115]
    s_and_b32 s32, s32, 0xffff
    v_mfma_f32_16x16x32_bf16 v[120:123], v[28:31], v[172:175], v[120:123]
    ds_read_b64_tr_b16 v[28:29], v56 offset:12288
    s_waitcnt lgkmcnt(6)
    v_mfma_f32_16x16x32_bf16 v[100:103], v[32:35], v[160:163], v[100:103]
    ds_read_b64_tr_b16 v[30:31], v57 offset:12288
    v_mfma_f32_16x16x32_bf16 v[108:111], v[32:35], v[164:167], v[108:111]
    s_add_u32 s31, s31, 24576
    v_mfma_f32_16x16x32_bf16 v[116:119], v[32:35], v[168:171], v[116:119]
    s_cmp_eq_u32 s31, 73728
    v_mfma_f32_16x16x32_bf16 v[124:127], v[32:35], v[172:175], v[124:127]
    ds_read_b64_tr_b16 v[32:33], v58 offset:12288
    v_mfma_f32_16x16x32_bf16 v[128:131], v[160:163], v[36:39], v[128:131]
    ds_read_b64_tr_b16 v[34:35], v59 offset:12288
    v_mfma_f32_16x16x32_bf16 v[132:135], v[164:167], v[36:39], v[132:135]
    s_cselect_b32 s31, 0, s31
    v_mfma_f32_16x16x32_bf16 v[144:147], v[168:171], v[36:39], v[144:147]
    s_add_u32 s30, s30, 1
    v_mfma_f32_16x16x32_bf16 v[148:151], v[172:175], v[36:39], v[148:151]
    ds_read_b64_tr_b16 v[36:37], v56 offset:20480
    v_mfma_f32_16x16x32_bf16 v[136:139], v[160:163], v[40:43], v[136:139]
    ds_read_b64_tr_b16 v[38:39], v57 offset:20480
    v_mfma_f32_16x16x32_bf16 v[140:143], v[164:167], v[40:43], v[140:143]
    s_cmp_lt_u32 s30, 16
    v_mfma_f32_16x16x32_bf16 v[152:155], v[168:171], v[40:43], v[152:155]
    v_add_u32 v52, s32, v44
    v_mfma_f32_16x16x32_bf16 v[156:159], v[172:175], v[40:43], v[156:159]
    ds_read_b64_tr_b16 v[40:41], v58 offset:20480
    v_mfma_f32_16x16x32_bf16 v[64:67], v[20:23], v[176:179], v[64:67]
    ds_read_b64_tr_b16 v[42:43], v59 offset:20480
    s_waitcnt lgkmcnt(4)
    v_mfma_f32_16x16x32_bf16 v[72:75], v[20:23], v[180:183], v[72:75]
    v_add_u32 v53, s32, v45
    v_add_u32 v58, s31, v50
    v_mfma_f32_16x16x32_bf16 v[80:83], v[20:23], v[184:187], v[80:83]
    v_add_u32 v54, s32, v46
    v_add_u32 v59, s31, v51
    v_mfma_f32_16x16x32_bf16 v[88:91], v[20:23], v[188:191], v[88:91]
    v_add_u32 v55, s32, v47
    v_mfma_f32_16x16x32_bf16 v[68:71], v[24:27], v[176:179], v[68:71]
    v_add_u32 v56, s31, v48
    v_mfma_f32_16x16x32_bf16 v[76:79], v[24:27], v[180:183], v[76:79]
    v_add_u32 v57, s31, v49
    v_mfma_f32_16x16x32_bf16 v[84:87], v[24:27], v[184:187], v[84:87]
    s_waitcnt lgkmcnt(0)
    v_mfma_f32_16x16x32_bf16 v[92:95], v[24:27], v[188:191], v[92:95]
    v_mfma_f32_16x16x32_bf16 v[96:99], v[28:31], v[176:179], v[96:99]
    v_mfma_f32_16x16x32_bf16 v[104:107], v[28:31], v[180:183], v[104:107]
    v_mfma_f32_16x16x32_bf16 v[112:115], v[28:31], v[184:187], v[112:115]
    v_mfma_f32_16x16x32_bf16 v[120:123], v[28:31], v[188:191], v[120:123]
    v_mfma_f32_16x16x32_bf16 v[100:103], v[32:35], v[176:179], v[100:103]
    v_mfma_f32_16x16x32_bf16 v[108:111], v[32:35], v[180:183], v[108:111]
    v_mfma_f32_16x16x32_bf16 v[116:119], v[32:35], v[184:187], v[116:119]
    v_mfma_f32_16x16x32_bf16 v[124:127], v[32:35], v[188:191], v[124:127]
    v_mfma_f32_16x16x32_bf16 v[128:131], v[176:179], v[36:39], v[128:131]
    v_mfma_f32_16x16x32_bf16 v[132:135], v[180:183], v[36:39], v[132:135]
    v_mfma_f32_16x16x32_bf16 v[144:147], v[184:187], v[36:39], v[144:147]
    v_mfma_f32_16x16x32_bf16 v[148:151], v[188:191], v[36:39], v[148:151]
    v_mfma_f32_16x16x32_bf16 v[136:139], v[176:179], v[40:43], v[136:139]
    v_mfma_f32_16x16x32_bf16 v[140:143], v[180:183], v[40:43], v[140:143]
    v_mfma_f32_16x16x32_bf16 v[152:155], v[184:187], v[40:43], v[152:155]
    v_mfma_f32_16x16x32_bf16 v[156:159], v[188:191], v[40:43], v[156:159]
    s_barrier
    ds_read_b128 v[160:163], v52 offset:0
    ds_read_b64_tr_b16 v[20:21], v56 offset:0
    ds_read_b64_tr_b16 v[22:23], v57 offset:0
    ds_read_b128 v[164:167], v53 offset:0
    ds_read_b128 v[168:171], v52 offset:4096
    ds_read_b128 v[172:175], v53 offset:4096
    ds_read_b64_tr_b16 v[24:25], v58 offset:0
    ds_read_b64_tr_b16 v[26:27], v59 offset:0
    ds_read_b64_tr_b16 v[28:29], v56 offset:8192
    ds_read_b64_tr_b16 v[30:31], v57 offset:8192
    ds_read_b64_tr_b16 v[32:33], v58 offset:8192
    ds_read_b64_tr_b16 v[34:35], v59 offset:8192
    ds_read_b64_tr_b16 v[36:37], v56 offset:16384
    ds_read_b64_tr_b16 v[38:39], v57 offset:16384
    ds_read_b64_tr_b16 v[40:41], v58 offset:16384
L_cons_13:
    s_waitcnt lgkmcnt(4)
    v_mfma_f32_16x16x32_bf16 v[64:67], v[20:23], v[160:163], v[64:67]
    ds_read_b64_tr_b16 v[42:43], v59 offset:16384
    v_mfma_f32_16x16x32_bf16 v[72:75], v[20:23], v[164:167], v[72:75]
    ds_read_b128 v[176:179], v54 offset:0
    v_mfma_f32_16x16x32_bf16 v[80:83], v[20:23], v[168:171], v[80:83]
    s_add_u32 s32, s32, 16384
    v_mfma_f32_16x16x32_bf16 v[88:91], v[20:23], v[172:175], v[88:91]
    ds_read_b64_tr_b16 v[20:21], v56 offset:4096
    v_mfma_f32_16x16x32_bf16 v[68:71], v[24:27], v[160:163], v[68:71]
    ds_read_b64_tr_b16 v[22:23], v57 offset:4096
    v_mfma_f32_16x16x32_bf16 v[76:79], v[24:27], v[164:167], v[76:79]
    ds_read_b128 v[180:183], v55 offset:0
    v_mfma_f32_16x16x32_bf16 v[84:87], v[24:27], v[168:171], v[84:87]
    ds_read_b128 v[184:187], v54 offset:4096
    v_mfma_f32_16x16x32_bf16 v[92:95], v[24:27], v[172:175], v[92:95]
    ds_read_b128 v[188:191], v55 offset:4096
    v_mfma_f32_16x16x32_bf16 v[96:99], v[28:31], v[160:163], v[96:99]
    ds_read_b64_tr_b16 v[24:25], v58 offset:4096
    v_mfma_f32_16x16x32_bf16 v[104:107], v[28:31], v[164:167], v[104:107]
    ds_read_b64_tr_b16 v[26:27], v59 offset:4096
    v_mfma_f32_16x16x32_bf16 v[112:115], v[28:31], v[168:171], v[112:115]
    s_and_b32 s32, s32, 0xffff
    v_mfma_f32_16x16x32_bf16 v[120:123], v[28:31], v[172:175], v[120:123]
    ds_read_b64_tr_b16 v[28:29], v56 offset:12288
    s_waitcnt lgkmcnt(6)
    v_mfma_f32_16x16x32_bf16 v[100:103], v[32:35], v[160:163], v[100:103]
    ds_read_b64_tr_b16 v[30:31], v57 offset:12288
    v_mfma_f32_16x16x32_bf16 v[108:111], v[32:35], v[164:167], v[108:111]
    s_add_u32 s31, s31, 24576
    v_mfma_f32_16x16x32_bf16 v[116:119], v[32:35], v[168:171], v[116:119]
    s_cmp_eq_u32 s31, 73728
    v_mfma_f32_16x16x32_bf16 v[124:127], v[32:35], v[172:175], v[124:127]
    ds_read_b64_tr_b16 v[32:33], v58 offset:12288
    v_mfma_f32_16x16x32_bf16 v[128:131], v[160:163], v[36:39], v[128:131]
    ds_read_b64_tr_b16 v[34:35], v59 offset:12288
    v_mfma_f32_16x16x32_bf16 v[132:135], v[164:167], v[36:39], v[132:135]
    s_cselect_b32 s31, 0, s31
    v_mfma_f32_16x16x32_bf16 v[144:147], v[168:171], v[36:39], v[144:147]
    s_add_u32 s30, s30, 1
    v_mfma_f32_16x16x32_bf16 v[148:151], v[172:175], v[36:39], v[148:151]
    ds_read_b64_tr_b16 v[36:37], v56 offset:20480
    v_mfma_f32_16x16x32_bf16 v[136:139], v[160:163], v[40:43], v[136:139]
    ds_read_b64_tr_b16 v[38:39], v57 offset:20480
    v_mfma_f32_16x16x32_bf16 v[140:143], v[164:167], v[40:43], v[140:143]
    s_cmp_lt_u32 s30, 4
    v_mfma_f32_16x16x32_bf16 v[152:155], v[168:171], v[40:43], v[152:155]
    v_add_u32 v52, s32, v44
    v_mfma_f32_16x16x32_bf16 v[156:159], v[172:175], v[40:43], v[156:159]
    ds_read_b64_tr_b16 v[40:41], v58 offset:20480
    v_mfma_f32_16x16x32_bf16 v[64:67], v[20:23], v[176:179], v[64:67]
    ds_read_b64_tr_b16 v[42:43], v59 offset:20480
    s_waitcnt lgkmcnt(4)
    v_mfma_f32_16x16x32_bf16 v[72:75], v[20:23], v[180:183], v[72:75]
    v_add_u32 v53, s32, v45
    v_add_u32 v58, s31, v50
    v_mfma_f32_16x16x32_bf16 v[80:83], v[20:23], v[184:187], v[80:83]
    v_add_u32 v54, s32, v46
    v_add_u32 v59, s31, v51
    v_mfma_f32_16x16x32_bf16 v[88:91], v[20:23], v[188:191], v[88:91]
    v_add_u32 v55, s32, v47
    v_mfma_f32_16x16x32_bf16 v[68:71], v[24:27], v[176:179], v[68:71]
    v_add_u32 v56, s31, v48
    v_mfma_f32_16x16x32_bf16 v[76:79], v[24:27], v[180:183], v[76:79]
    v_add_u32 v57, s31, v49
    v_mfma_f32_16x16x32_bf16 v[84:87], v[24:27], v[184:187], v[84:87]
    s_waitcnt lgkmcnt(0)
    s_barrier
    v_mfma_f32_16x16x32_bf16 v[92:95], v[24:27], v[188:191], v[92:95]
    ds_read_b128 v[160:163], v52 offset:0
    ds_read_b64_tr_b16 v[20:21], v56 offset:0
    v_mfma_f32_16x16x32_bf16 v[96:99], v[28:31], v[176:179], v[96:99]
    ds_read_b64_tr_b16 v[22:23], v57 offset:0
    v_mfma_f32_16x16x32_bf16 v[104:107], v[28:31], v[180:183], v[104:107]
    ds_read_b128 v[164:167], v53 offset:0
    v_mfma_f32_16x16x32_bf16 v[112:115], v[28:31], v[184:187], v[112:115]
    ds_read_b128 v[168:171], v52 offset:4096
    v_mfma_f32_16x16x32_bf16 v[120:123], v[28:31], v[188:191], v[120:123]
    ds_read_b128 v[172:175], v53 offset:4096
    v_mfma_f32_16x16x32_bf16 v[100:103], v[32:35], v[176:179], v[100:103]
    ds_read_b64_tr_b16 v[24:25], v58 offset:0
    v_mfma_f32_16x16x32_bf16 v[108:111], v[32:35], v[180:183], v[108:111]
    ds_read_b64_tr_b16 v[26:27], v59 offset:0
    v_mfma_f32_16x16x32_bf16 v[116:119], v[32:35], v[184:187], v[116:119]
    ds_read_b64_tr_b16 v[28:29], v56 offset:8192
    v_mfma_f32_16x16x32_bf16 v[124:127], v[32:35], v[188:191], v[124:127]
    ds_read_b64_tr_b16 v[30:31], v57 offset:8192
    v_mfma_f32_16x16x32_bf16 v[128:131], v[176:179], v[36:39], v[128:131]
    ds_read_b64_tr_b16 v[32:33], v58 offset:8192
    v_mfma_f32_16x16x32_bf16 v[132:135], v[180:183], v[36:39], v[132:135]
    ds_read_b64_tr_b16 v[34:35], v59 offset:8192
    v_mfma_f32_16x16x32_bf16 v[144:147], v[184:187], v[36:39], v[144:147]
    v_mfma_f32_16x16x32_bf16 v[148:151], v[188:191], v[36:39], v[148:151]
    ds_read_b64_tr_b16 v[36:37], v56 offset:16384
    v_mfma_f32_16x16x32_bf16 v[136:139], v[176:179], v[40:43], v[136:139]
    ds_read_b64_tr_b16 v[38:39], v57 offset:16384
    v_mfma_f32_16x16x32_bf16 v[140:143], v[180:183], v[40:43], v[140:143]
    v_mfma_f32_16x16x32_bf16 v[152:155], v[184:187], v[40:43], v[152:155]
    v_mfma_f32_16x16x32_bf16 v[156:159], v[188:191], v[40:43], v[156:159]
    ds_read_b64_tr_b16 v[40:41], v58 offset:16384
    s_cbranch_scc1 L_cons_13
    s_cmp_eq_u32 s23, 0
    s_cbranch_scc0 L_qkv_s0
    s_waitcnt vmcnt(4)
    v_mov_b32 v3, 0x3f803f80
    v_mov_b32 v12, 0
    v_mov_b32 v13, 0
    v_mov_b32 v14, 0
    v_mov_b32 v15, 0
    v_mov_b32 v16, 0
    v_mov_b32 v17, 0
    v_mov_b32 v18, 0
    v_mov_b32 v19, 0
    v_dot2_f32_bf16 v12, v240, v3, v12
    v_dot2_f32_bf16 v13, v240, v240, v13
    v_dot2_f32_bf16 v14, v244, v3, v14
    v_dot2_f32_bf16 v15, v244, v244, v15
    v_dot2_f32_bf16 v16, v248, v3, v16
    v_dot2_f32_bf16 v17, v248, v248, v17
    v_dot2_f32_bf16 v18, v252, v3, v18
    v_dot2_f32_bf16 v19, v252, v252, v19
    v_dot2_f32_bf16 v12, v241, v3, v12
    v_dot2_f32_bf16 v13, v241, v241, v13
    v_dot2_f32_bf16 v14, v245, v3, v14
    v_dot2_f32_bf16 v15, v245, v245, v15
    v_dot2_f32_bf16 v16, v249, v3, v16
    v_dot2_f32_bf16 v17, v249, v249, v17
    v_dot2_f32_bf16 v18, v253, v3, v18
    v_dot2_f32_bf16 v19, v253, v253, v19
    v_dot2_f32_bf16 v12, v242, v3, v12
    v_dot2_f32_bf16 v13, v242, v242, v13
    v_dot2_f32_bf16 v14, v246, v3, v14
    v_dot2_f32_bf16 v15, v246, v246, v15
    v_dot2_f32_bf16 v16, v250, v3, v16
    v_dot2_f32_bf16 v17, v250, v250, v17
    v_dot2_f32_bf16 v18, v254, v3, v18
    v_dot2_f32_bf16 v19, v254, v254, v19
    v_dot2_f32_bf16 v12, v243, v3, v12
    v_dot2_f32_bf16 v13, v243, v243, v13
    v_dot2_f32_bf16 v14, v247, v3, v14
    v_dot2_f32_bf16 v15, v247, v247, v15
    v_dot2_f32_bf16 v16, v251, v3, v16
    v_dot2_f32_bf16 v17, v251, v251, v17
    v_dot2_f32_bf16 v18, v255, v3, v18
    v_dot2_f32_bf16 v19, v255, v255, v19
    s_lshl_b32 s27, s6, 14
    s_lshl_b32 s28, s21, 10
    s_add_u32 s27, s27, s28
    s_lshl_b32 s28, s89, 3
    s_add_u32 s27, s27, s28
    s_add_u32 s27, s27, 0x1600000
    v_permlane32_swap_b32 v12, v16
    v_permlane32_swap_b32 v13, v17
    v_permlane32_swap_b32 v14, v18
    v_permlane32_swap_b32 v15, v19
    v_add_f32 v12, v12, v16
    v_add_f32 v13, v13, v17
    v_add_f32 v14, v14, v18
    v_add_f32 v15, v15, v19
    s_nop 1
    v_permlane16_swap_b32 v12, v14
    v_permlane16_swap_b32 v13, v15
    v_add_f32 v16, v12, v14
    v_add_f32 v17, v13, v15
    buffer_store_dwordx2 v[16:17], v2, s[8:11], s27 offen sc1
L_qkv_s0:
L_cons_14:
    s_waitcnt lgkmcnt(4)
    v_mfma_f32_16x16x32_bf16 v[64:67], v[20:23], v[160:163], v[64:67]
    ds_read_b64_tr_b16 v[42:43], v59 offset:16384
    v_mfma_f32_16x16x32_bf16 v[72:75], v[20:23], v[164:167], v[72:75]
    ds_read_b128 v[176:179], v54 offset:0
    v_mfma_f32_16x16x32_bf16 v[80:83], v[20:23], v[168:171], v[80:83]
    s_add_u32 s32, s32, 16384
    v_mfma_f32_16x16x32_bf16 v[88:91], v[20:23], v[172:175], v[88:91]
    ds_read_b64_tr_b16 v[20:21], v56 offset:4096
    v_mfma_f32_16x16x32_bf16 v[68:71], v[24:27], v[160:163], v[68:71]
    ds_read_b64_tr_b16 v[22:23], v57 offset:4096
    v_mfma_f32_16x16x32_bf16 v[76:79], v[24:27], v[164:167], v[76:79]
    ds_read_b128 v[180:183], v55 offset:0
    v_mfma_f32_16x16x32_bf16 v[84:87], v[24:27], v[168:171], v[84:87]
    ds_read_b128 v[184:187], v54 offset:4096
    v_mfma_f32_16x16x32_bf16 v[92:95], v[24:27], v[172:175], v[92:95]
    ds_read_b128 v[188:191], v55 offset:4096
    v_mfma_f32_16x16x32_bf16 v[96:99], v[28:31], v[160:163], v[96:99]
    ds_read_b64_tr_b16 v[24:25], v58 offset:4096
    v_mfma_f32_16x16x32_bf16 v[104:107], v[28:31], v[164:167], v[104:107]
    ds_read_b64_tr_b16 v[26:27], v59 offset:4096
    v_mfma_f32_16x16x32_bf16 v[112:115], v[28:31], v[168:171], v[112:115]
    s_and_b32 s32, s32, 0xffff
    v_mfma_f32_16x16x32_bf16 v[120:123], v[28:31], v[172:175], v[120:123]
    ds_read_b64_tr_b16 v[28:29], v56 offset:12288
    s_waitcnt lgkmcnt(6)
    v_mfma_f32_16x16x32_bf16 v[100:103], v[32:35], v[160:163], v[100:103]
    ds_read_b64_tr_b16 v[30:31], v57 offset:12288
    v_mfma_f32_16x16x32_bf16 v[108:111], v[32:35], v[164:167], v[108:111]
    s_add_u32 s31, s31, 24576
    v_mfma_f32_16x16x32_bf16 v[116:119], v[32:35], v[168:171], v[116:119]
    s_cmp_eq_u32 s31, 73728
    v_mfma_f32_16x16x32_bf16 v[124:127], v[32:35], v[172:175], v[124:127]
    ds_read_b64_tr_b16 v[32:33], v58 offset:12288
    v_mfma_f32_16x16x32_bf16 v[128:131], v[160:163], v[36:39], v[128:131]
    ds_read_b64_tr_b16 v[34:35], v59 offset:12288
    v_mfma_f32_16x16x32_bf16 v[132:135], v[164:167], v[36:39], v[132:135]
    s_cselect_b32 s31, 0, s31
    v_mfma_f32_16x16x32_bf16 v[144:147], v[168:171], v[36:39], v[144:147]
    s_add_u32 s30, s30, 1
    v_mfma_f32_16x16x32_bf16 v[148:151], v[172:175], v[36:39], v[148:151]
    ds_read_b64_tr_b16 v[36:37], v56 offset:20480
    v_mfma_f32_16x16x32_bf16 v[136:139], v[160:163], v[40:43], v[136:139]
    ds_read_b64_tr_b16 v[38:39], v57 offset:20480
    v_mfma_f32_16x16x32_bf16 v[140:143], v[164:167], v[40:43], v[140:143]
    s_cmp_lt_u32 s30, 8
    v_mfma_f32_16x16x32_bf16 v[152:155], v[168:171], v[40:43], v[152:155]
    v_add_u32 v52, s32, v44
    v_mfma_f32_16x16x32_bf16 v[156:159], v[172:175], v[40:43], v[156:159]
    ds_read_b64_tr_b16 v[40:41], v58 offset:20480
    v_mfma_f32_16x16x32_bf16 v[64:67], v[20:23], v[176:179], v[64:67]
    ds_read_b64_tr_b16 v[42:43], v59 offset:20480
    s_waitcnt lgkmcnt(4)
    v_mfma_f32_16x16x32_bf16 v[72:75], v[20:23], v[180:183], v[72:75]
    v_add_u32 v53, s32, v45
    v_add_u32 v58, s31, v50
    v_mfma_f32_16x16x32_bf16 v[80:83], v[20:23], v[184:187], v[80:83]
    v_add_u32 v54, s32, v46
    v_add_u32 v59, s31, v51
    v_mfma_f32_16x16x32_bf16 v[88:91], v[20:23], v[188:191], v[88:91]
    v_add_u32 v55, s32, v47
    v_mfma_f32_16x16x32_bf16 v[68:71], v[24:27], v[176:179], v[68:71]
    v_add_u32 v56, s31, v48
    v_mfma_f32_16x16x32_bf16 v[76:79], v[24:27], v[180:183], v[76:79]
    v_add_u32 v57, s31, v49
    v_mfma_f32_16x16x32_bf16 v[84:87], v[24:27], v[184:187], v[84:87]
    s_waitcnt lgkmcnt(0)
    s_barrier
    v_mfma_f32_16x16x32_bf16 v[92:95], v[24:27], v[188:191], v[92:95]
    ds_read_b128 v[160:163], v52 offset:0
    ds_read_b64_tr_b16 v[20:21], v56 offset:0
    v_mfma_f32_16x16x32_bf16 v[96:99], v[28:31], v[176:179], v[96:99]
    ds_read_b64_tr_b16 v[22:23], v57 offset:0
    v_mfma_f32_16x16x32_bf16 v[104:107], v[28:31], v[180:183], v[104:107]
    ds_read_b128 v[164:167], v53 offset:0
    v_mfma_f32_16x16x32_bf16 v[112:115], v[28:31], v[184:187], v[112:115]
    ds_read_b128 v[168:171], v52 offset:4096
    v_mfma_f32_16x16x32_bf16 v[120:123], v[28:31], v[188:191], v[120:123]
    ds_read_b128 v[172:175], v53 offset:4096
    v_mfma_f32_16x16x32_bf16 v[100:103], v[32:35], v[176:179], v[100:103]
    ds_read_b64_tr_b16 v[24:25], v58 offset:0
    v_mfma_f32_16x16x32_bf16 v[108:111], v[32:35], v[180:183], v[108:111]
    ds_read_b64_tr_b16 v[26:27], v59 offset:0
    v_mfma_f32_16x16x32_bf16 v[116:119], v[32:35], v[184:187], v[116:119]
    ds_read_b64_tr_b16 v[28:29], v56 offset:8192
    v_mfma_f32_16x16x32_bf16 v[124:127], v[32:35], v[188:191], v[124:127]
    ds_read_b64_tr_b16 v[30:31], v57 offset:8192
    v_mfma_f32_16x16x32_bf16 v[128:131], v[176:179], v[36:39], v[128:131]
    ds_read_b64_tr_b16 v[32:33], v58 offset:8192
    v_mfma_f32_16x16x32_bf16 v[132:135], v[180:183], v[36:39], v[132:135]
    ds_read_b64_tr_b16 v[34:35], v59 offset:8192
    v_mfma_f32_16x16x32_bf16 v[144:147], v[184:187], v[36:39], v[144:147]
    v_mfma_f32_16x16x32_bf16 v[148:151], v[188:191], v[36:39], v[148:151]
    ds_read_b64_tr_b16 v[36:37], v56 offset:16384
    v_mfma_f32_16x16x32_bf16 v[136:139], v[176:179], v[40:43], v[136:139]
    ds_read_b64_tr_b16 v[38:39], v57 offset:16384
    v_mfma_f32_16x16x32_bf16 v[140:143], v[180:183], v[40:43], v[140:143]
    v_mfma_f32_16x16x32_bf16 v[152:155], v[184:187], v[40:43], v[152:155]
    v_mfma_f32_16x16x32_bf16 v[156:159], v[188:191], v[40:43], v[156:159]
    ds_read_b64_tr_b16 v[40:41], v58 offset:16384
    s_cbranch_scc1 L_cons_14
    s_cmp_eq_u32 s23, 0
    s_cbranch_scc0 L_qkv_sf
    s_lshl_b32 s27, s6, 9
    s_lshl_b32 s28, s7, 4
    s_add_u32 s27, s27, s28
    s_add_u32 s27, s27, 0x1a00000
    v_mov_b32 v4, 0
    v_mov_b32 v5, s78
    s_waitcnt vmcnt(0)
    s_mov_b64 exec, 1
    buffer_store_dword v5, v4, s[8:11], s27 offen sc1
    s_mov_b64 exec, -1
L_qkv_sf:
L_cons_15:
    s_waitcnt lgkmcnt(4)
    v_mfma_f32_16x16x32_bf16 v[64:67], v[20:23], v[160:163], v[64:67]
    ds_read_b64_tr_b16 v[42:43], v59 offset:16384
    v_mfma_f32_16x16x32_bf16 v[72:75], v[20:23], v[164:167], v[72:75]
    ds_read_b128 v[176:179], v54 offset:0
    v_mfma_f32_16x16x32_bf16 v[80:83], v[20:23], v[168:171], v[80:83]
    s_add_u32 s32, s32, 16384
    v_mfma_f32_16x16x32_bf16 v[88:91], v[20:23], v[172:175], v[88:91]
    ds_read_b64_tr_b16 v[20:21], v56 offset:4096
    v_mfma_f32_16x16x32_bf16 v[68:71], v[24:27], v[160:163], v[68:71]
    ds_read_b64_tr_b16 v[22:23], v57 offset:4096
    v_mfma_f32_16x16x32_bf16 v[76:79], v[24:27], v[164:167], v[76:79]
    ds_read_b128 v[180:183], v55 offset:0
    v_mfma_f32_16x16x32_bf16 v[84:87], v[24:27], v[168:171], v[84:87]
    ds_read_b128 v[184:187], v54 offset:4096
    v_mfma_f32_16x16x32_bf16 v[92:95], v[24:27], v[172:175], v[92:95]
    ds_read_b128 v[188:191], v55 offset:4096
    v_mfma_f32_16x16x32_bf16 v[96:99], v[28:31], v[160:163], v[96:99]
    ds_read_b64_tr_b16 v[24:25], v58 offset:4096
    v_mfma_f32_16x16x32_bf16 v[104:107], v[28:31], v[164:167], v[104:107]
    ds_read_b64_tr_b16 v[26:27], v59 offset:4096
    v_mfma_f32_16x16x32_bf16 v[112:115], v[28:31], v[168:171], v[112:115]
    s_and_b32 s32, s32, 0xffff
    v_mfma_f32_16x16x32_bf16 v[120:123], v[28:31], v[172:175], v[120:123]
    ds_read_b64_tr_b16 v[28:29], v56 offset:12288
    s_waitcnt lgkmcnt(6)
    v_mfma_f32_16x16x32_bf16 v[100:103], v[32:35], v[160:163], v[100:103]
    ds_read_b64_tr_b16 v[30:31], v57 offset:12288
    v_mfma_f32_16x16x32_bf16 v[108:111], v[32:35], v[164:167], v[108:111]
    s_add_u32 s31, s31, 24576
    v_mfma_f32_16x16x32_bf16 v[116:119], v[32:35], v[168:171], v[116:119]
    s_cmp_eq_u32 s31, 73728
    v_mfma_f32_16x16x32_bf16 v[124:127], v[32:35], v[172:175], v[124:127]
    ds_read_b64_tr_b16 v[32:33], v58 offset:12288
    v_mfma_f32_16x16x32_bf16 v[128:131], v[160:163], v[36:39], v[128:131]
    ds_read_b64_tr_b16 v[34:35], v59 offset:12288
    v_mfma_f32_16x16x32_bf16 v[132:135], v[164:167], v[36:39], v[132:135]
    s_cselect_b32 s31, 0, s31
    v_mfma_f32_16x16x32_bf16 v[144:147], v[168:171], v[36:39], v[144:147]
    s_add_u32 s30, s30, 1
    v_mfma_f32_16x16x32_bf16 v[148:151], v[172:175], v[36:39], v[148:151]
    ds_read_b64_tr_b16 v[36:37], v56 offset:20480
    v_mfma_f32_16x16x32_bf16 v[136:139], v[160:163], v[40:43], v[136:139]
    ds_read_b64_tr_b16 v[38:39], v57 offset:20480
    v_mfma_f32_16x16x32_bf16 v[140:143], v[164:167], v[40:43], v[140:143]
    s_cmp_lt_u32 s30, 16
    v_mfma_f32_16x16x32_bf16 v[152:155], v[168:171], v[40:43], v[152:155]
    v_add_u32 v52, s32, v44
    v_mfma_f32_16x16x32_bf16 v[156:159], v[172:175], v[40:43], v[156:159]
    ds_read_b64_tr_b16 v[40:41], v58 offset:20480
    v_mfma_f32_16x16x32_bf16 v[64:67], v[20:23], v[176:179], v[64:67]
    ds_read_b64_tr_b16 v[42:43], v59 offset:20480
    s_waitcnt lgkmcnt(4)
    v_mfma_f32_16x16x32_bf16 v[72:75], v[20:23], v[180:183], v[72:75]
    v_add_u32 v53, s32, v45
    v_add_u32 v58, s31, v50
    v_mfma_f32_16x16x32_bf16 v[80:83], v[20:23], v[184:187], v[80:83]
    v_add_u32 v54, s32, v46
    v_add_u32 v59, s31, v51
    v_mfma_f32_16x16x32_bf16 v[88:91], v[20:23], v[188:191], v[88:91]
    v_add_u32 v55, s32, v47
    v_mfma_f32_16x16x32_bf16 v[68:71], v[24:27], v[176:179], v[68:71]
    v_add_u32 v56, s31, v48
    v_mfma_f32_16x16x32_bf16 v[76:79], v[24:27], v[180:183], v[76:79]
    v_add_u32 v57, s31, v49
    v_mfma_f32_16x16x32_bf16 v[84:87], v[24:27], v[184:187], v[84:87]
    s_waitcnt lgkmcnt(0)
    s_barrier
    v_mfma_f32_16x16x32_bf16 v[92:95], v[24:27], v[188:191], v[92:95]
    ds_read_b128 v[160:163], v52 offset:0
    ds_read_b64_tr_b16 v[20:21], v56 offset:0
    v_mfma_f32_16x16x32_bf16 v[96:99], v[28:31], v[176:179], v[96:99]
    ds_read_b64_tr_b16 v[22:23], v57 offset:0
    v_mfma_f32_16x16x32_bf16 v[104:107], v[28:31], v[180:183], v[104:107]
    ds_read_b128 v[164:167], v53 offset:0
    v_mfma_f32_16x16x32_bf16 v[112:115], v[28:31], v[184:187], v[112:115]
    ds_read_b128 v[168:171], v52 offset:4096
    v_mfma_f32_16x16x32_bf16 v[120:123], v[28:31], v[188:191], v[120:123]
    ds_read_b128 v[172:175], v53 offset:4096
    v_mfma_f32_16x16x32_bf16 v[100:103], v[32:35], v[176:179], v[100:103]
    ds_read_b64_tr_b16 v[24:25], v58 offset:0
    v_mfma_f32_16x16x32_bf16 v[108:111], v[32:35], v[180:183], v[108:111]
    ds_read_b64_tr_b16 v[26:27], v59 offset:0
    v_mfma_f32_16x16x32_bf16 v[116:119], v[32:35], v[184:187], v[116:119]
    ds_read_b64_tr_b16 v[28:29], v56 offset:8192
    v_mfma_f32_16x16x32_bf16 v[124:127], v[32:35], v[188:191], v[124:127]
    ds_read_b64_tr_b16 v[30:31], v57 offset:8192
    v_mfma_f32_16x16x32_bf16 v[128:131], v[176:179], v[36:39], v[128:131]
    ds_read_b64_tr_b16 v[32:33], v58 offset:8192
    v_mfma_f32_16x16x32_bf16 v[132:135], v[180:183], v[36:39], v[132:135]
    ds_read_b64_tr_b16 v[34:35], v59 offset:8192
    v_mfma_f32_16x16x32_bf16 v[144:147], v[184:187], v[36:39], v[144:147]
    v_mfma_f32_16x16x32_bf16 v[148:151], v[188:191], v[36:39], v[148:151]
    ds_read_b64_tr_b16 v[36:37], v56 offset:16384
    v_mfma_f32_16x16x32_bf16 v[136:139], v[176:179], v[40:43], v[136:139]
    ds_read_b64_tr_b16 v[38:39], v57 offset:16384
    v_mfma_f32_16x16x32_bf16 v[140:143], v[180:183], v[40:43], v[140:143]
    v_mfma_f32_16x16x32_bf16 v[152:155], v[184:187], v[40:43], v[152:155]
    v_mfma_f32_16x16x32_bf16 v[156:159], v[188:191], v[40:43], v[156:159]
    ds_read_b64_tr_b16 v[40:41], v58 offset:16384
    s_cbranch_scc1 L_cons_15
    s_waitcnt lgkmcnt(0)
    s_lshl_b32 s27, s88, 8
    s_add_u32 s27, s27, 155648
    v_and_b32 v3, 15, v1
    v_lshlrev_b32 v4, 2, v3
    v_add_u32 v5, s27, v4
    v_lshrrev_b32 v6, 4, v1
    v_lshlrev_b32 v7, 4, v6
    v_add_u32 v8, s27, v7
    s_lshl_b32 s28, s89, 7
    s_add_u32 s28, s28, 156672
    v_add_u32 v7, s28, v7
    v_add_u32 v4, s28, v4
    ds_read_b32 v20, v5 offset:0
    ds_read_b32 v28, v5 offset:512
    ds_read_b32 v22, v5 offset:64
    ds_read_b32 v30, v5 offset:576
    ds_read_b32 v24, v5 offset:128
    ds_read_b32 v32, v5 offset:640
    ds_read_b32 v26, v5 offset:192
    ds_read_b32 v34, v5 offset:704
    ds_read_b128 v[160:163], v7 offset:256
    ds_read_b128 v[164:167], v7 offset:320
    ds_read_b32 v44, v4 offset:512
    ds_read_b32 v46, v4 offset:576
    ds_read_b128 v[176:179], v8 offset:0
    ds_read_b128 v[192:195], v8 offset:512
    ds_read_b128 v[180:183], v8 offset:64
    ds_read_b128 v[196:199], v8 offset:576
    ds_read_b128 v[184:187], v8 offset:128
    ds_read_b128 v[200:203], v8 offset:640
    ds_read_b128 v[188:191], v8 offset:192
    ds_read_b128 v[204:207], v8 offset:704
    ds_read_b128 v[168:171], v7 offset:0
    ds_read_b128 v[172:175], v7 offset:64
    v_lshlrev_b32 v6, 9, v6
    v_and_b32 v9, 8, v3
    v_add_u32 v9, v9, v3
    v_lshlrev_b32 v9, 4, v9
    v_add_u32 v60, v6, v9
    v_lshlrev_b32 v9, 4, v3
    v_add_u32 v62, v6, v9
    s_lshl_b32 s47, s6, 1
    s_mul_i32 s29, s47, 229376
    s_lshl_b32 s27, s51, 11
    s_lshl_b32 s28, s89, 12
    s_add_u32 s29, s29, s27
    s_add_u32 s29, s29, s28
    s_add_u32 s29, s29, 0x100000
    s_add_u32 s30, s29, 229376
    s_xor_b32 s27, s89, 1
    s_lshl_b32 s27, s27, 16
    s_lshl_b32 s28, s88, 13
    s_add_u32 s27, s27, s28
    v_add_u32 v61, s27, v60
    s_lshl_b32 s27, s89, 13
    s_lshl_b32 s28, s88, 12
    s_add_u32 s27, s27, s28
    s_add_u32 s27, s27, 131072
    v_add_u32 v62, s27, v62
    s_waitcnt lgkmcnt(12)
    v_pk_fma_f32 v[96:97], v[160:161], v[20:21], v[96:97] op_sel_hi:[1,0,1]
    v_pk_fma_f32 v[98:99], v[162:163], v[20:21], v[98:99] op_sel_hi:[1,0,1]
    v_pk_fma_f32 v[100:101], v[164:165], v[20:21], v[100:101] op_sel_hi:[1,0,1]
    v_pk_fma_f32 v[102:103], v[166:167], v[20:21], v[102:103] op_sel_hi:[1,0,1]
    v_pk_mul_f32 v[96:97], v[96:97], v[28:29] op_sel_hi:[1,0]
    v_pk_mul_f32 v[98:99], v[98:99], v[28:29] op_sel_hi:[1,0]
    v_pk_mul_f32 v[100:101], v[100:101], v[28:29] op_sel_hi:[1,0]
    v_pk_mul_f32 v[102:103], v[102:103], v[28:29] op_sel_hi:[1,0]
    v_cvt_pk_bf16_f32 v96, v96, v97
    v_cvt_pk_bf16_f32 v97, v98, v99
    v_cvt_pk_bf16_f32 v98, v100, v101
    v_cvt_pk_bf16_f32 v99, v102, v103
    s_waitcnt lgkmcnt(0)
    buffer_store_dwordx4 v[96:99], v60, s[8:11], s29 offen offset:0 sc1
    ds_write_b128 v61, v[96:99] offset:0
    v_pk_fma_f32 v[104:105], v[160:161], v[22:23], v[104:105] op_sel_hi:[1,0,1]
    v_pk_fma_f32 v[106:107], v[162:163], v[22:23], v[106:107] op_sel_hi:[1,0,1]
    v_pk_fma_f32 v[108:109], v[164:165], v[22:23], v[108:109] op_sel_hi:[1,0,1]
    v_pk_fma_f32 v[110:111], v[166:167], v[22:23], v[110:111] op_sel_hi:[1,0,1]
    v_pk_mul_f32 v[104:105], v[104:105], v[30:31] op_sel_hi:[1,0]
    v_pk_mul_f32 v[106:107], v[106:107], v[30:31] op_sel_hi:[1,0]
    v_pk_mul_f32 v[108:109], v[108:109], v[30:31] op_sel_hi:[1,0]
    v_pk_mul_f32 v[110:111], v[110:111], v[30:31] op_sel_hi:[1,0]
    v_cvt_pk_bf16_f32 v104, v104, v105
    v_cvt_pk_bf16_f32 v105, v106, v107
    v_cvt_pk_bf16_f32 v106, v108, v109
    v_cvt_pk_bf16_f32 v107, v110, v111
    buffer_store_dwordx4 v[104:107], v60, s[8:11], s29 offen offset:128 sc1
    ds_write_b128 v61, v[104:107] offset:128
    v_pk_fma_f32 v[112:113], v[160:161], v[24:25], v[112:113] op_sel_hi:[1,0,1]
    v_pk_fma_f32 v[114:115], v[162:163], v[24:25], v[114:115] op_sel_hi:[1,0,1]
    v_pk_fma_f32 v[116:117], v[164:165], v[24:25], v[116:117] op_sel_hi:[1,0,1]
    v_pk_fma_f32 v[118:119], v[166:167], v[24:25], v[118:119] op_sel_hi:[1,0,1]
    v_pk_mul_f32 v[112:113], v[112:113], v[32:33] op_sel_hi:[1,0]
    v_pk_mul_f32 v[114:115], v[114:115], v[32:33] op_sel_hi:[1,0]
    v_pk_mul_f32 v[116:117], v[116:117], v[32:33] op_sel_hi:[1,0]
    v_pk_mul_f32 v[118:119], v[118:119], v[32:33] op_sel_hi:[1,0]
    v_cvt_pk_bf16_f32 v112, v112, v113
    v_cvt_pk_bf16_f32 v113, v114, v115
    v_cvt_pk_bf16_f32 v114, v116, v117
    v_cvt_pk_bf16_f32 v115, v118, v119
    buffer_store_dwordx4 v[112:115], v60, s[8:11], s30 offen offset:0 sc1
    ds_write_b128 v61, v[112:115] offset:4096
    v_pk_fma_f32 v[120:121], v[160:161], v[26:27], v[120:121] op_sel_hi:[1,0,1]
    v_pk_fma_f32 v[122:123], v[162:163], v[26:27], v[122:123] op_sel_hi:[1,0,1]
    v_pk_fma_f32 v[124:125], v[164:165], v[26:27], v[124:125] op_sel_hi:[1,0,1]
    v_pk_fma_f32 v[126:127], v[166:167], v[26:27], v[126:127] op_sel_hi:[1,0,1]
    v_pk_mul_f32 v[120:121], v[120:121], v[34:35] op_sel_hi:[1,0]
    v_pk_mul_f32 v[122:123], v[122:123], v[34:35] op_sel_hi:[1,0]
    v_pk_mul_f32 v[124:125], v[124:125], v[34:35] op_sel_hi:[1,0]
    v_pk_mul_f32 v[126:127], v[126:127], v[34:35] op_sel_hi:[1,0]
    v_cvt_pk_bf16_f32 v120, v120, v121
    v_cvt_pk_bf16_f32 v121, v122, v123
    v_cvt_pk_bf16_f32 v122, v124, v125
    v_cvt_pk_bf16_f32 v123, v126, v127
    buffer_store_dwordx4 v[120:123], v60, s[8:11], s30 offen offset:128 sc1
    ds_write_b128 v61, v[120:123] offset:4224
    v_pk_fma_f32 v[128:129], v[176:177], v[44:45], v[128:129] op_sel_hi:[1,0,1]
    v_pk_fma_f32 v[130:131], v[178:179], v[44:45], v[130:131] op_sel_hi:[1,0,1]
    v_pk_fma_f32 v[132:133], v[180:181], v[44:45], v[132:133] op_sel_hi:[1,0,1]
    v_pk_fma_f32 v[134:135], v[182:183], v[44:45], v[134:135] op_sel_hi:[1,0,1]
    v_pk_mul_f32 v[128:129], v[128:129], v[192:193]
    v_pk_mul_f32 v[130:131], v[130:131], v[194:195]
    v_pk_mul_f32 v[132:133], v[132:133], v[196:197]
    v_pk_mul_f32 v[134:135], v[134:135], v[198:199]
    v_cvt_pk_bf16_f32 v128, v128, v129
    v_cvt_pk_bf16_f32 v129, v130, v131
    v_cvt_pk_bf16_f32 v130, v132, v133
    v_cvt_pk_bf16_f32 v131, v134, v135
    buffer_store_dwordx4 v[128:131], v60, s[8:11], s29 offen offset:2048 sc1
    ds_write_b128 v61, v[128:131] offset:2048
    v_pk_fma_f32 v[136:137], v[176:177], v[46:47], v[136:137] op_sel_hi:[1,0,1]
    v_pk_fma_f32 v[138:139], v[178:179], v[46:47], v[138:139] op_sel_hi:[1,0,1]
    v_pk_fma_f32 v[140:141], v[180:181], v[46:47], v[140:141] op_sel_hi:[1,0,1]
    v_pk_fma_f32 v[142:143], v[182:183], v[46:47], v[142:143] op_sel_hi:[1,0,1]
    v_pk_mul_f32 v[136:137], v[136:137], v[192:193]
    v_pk_mul_f32 v[138:139], v[138:139], v[194:195]
    v_pk_mul_f32 v[140:141], v[140:141], v[196:197]
    v_pk_mul_f32 v[142:143], v[142:143], v[198:199]
    v_cvt_pk_bf16_f32 v136, v136, v137
    v_cvt_pk_bf16_f32 v137, v138, v139
    v_cvt_pk_bf16_f32 v138, v140, v141
    v_cvt_pk_bf16_f32 v139, v142, v143
    buffer_store_dwordx4 v[136:139], v60, s[8:11], s29 offen offset:2176 sc1
    ds_write_b128 v61, v[136:139] offset:2176
    v_pk_fma_f32 v[144:145], v[184:185], v[44:45], v[144:145] op_sel_hi:[1,0,1]
    v_pk_fma_f32 v[146:147], v[186:187], v[44:45], v[146:147] op_sel_hi:[1,0,1]
    v_pk_fma_f32 v[148:149], v[188:189], v[44:45], v[148:149] op_sel_hi:[1,0,1]
    v_pk_fma_f32 v[150:151], v[190:191], v[44:45], v[150:151] op_sel_hi:[1,0,1]
    v_pk_mul_f32 v[144:145], v[144:145], v[200:201]
    v_pk_mul_f32 v[146:147], v[146:147], v[202:203]
    v_pk_mul_f32 v[148:149], v[148:149], v[204:205]
    v_pk_mul_f32 v[150:151], v[150:151], v[206:207]
    v_cvt_pk_bf16_f32 v144, v144, v145
    v_cvt_pk_bf16_f32 v145, v146, v147
    v_cvt_pk_bf16_f32 v146, v148, v149
    v_cvt_pk_bf16_f32 v147, v150, v151
    buffer_store_dwordx4 v[144:147], v60, s[8:11], s30 offen offset:2048 sc1
    ds_write_b128 v61, v[144:147] offset:6144
    v_pk_fma_f32 v[152:153], v[184:185], v[46:47], v[152:153] op_sel_hi:[1,0,1]
    v_pk_fma_f32 v[154:155], v[186:187], v[46:47], v[154:155] op_sel_hi:[1,0,1]
    v_pk_fma_f32 v[156:157], v[188:189], v[46:47], v[156:157] op_sel_hi:[1,0,1]
    v_pk_fma_f32 v[158:159], v[190:191], v[46:47], v[158:159] op_sel_hi:[1,0,1]
    v_pk_mul_f32 v[152:153], v[152:153], v[200:201]
    v_pk_mul_f32 v[154:155], v[154:155], v[202:203]
    v_pk_mul_f32 v[156:157], v[156:157], v[204:205]
    v_pk_mul_f32 v[158:159], v[158:159], v[206:207]
    v_cvt_pk_bf16_f32 v152, v152, v153
    v_cvt_pk_bf16_f32 v153, v154, v155
    v_cvt_pk_bf16_f32 v154, v156, v157
    v_cvt_pk_bf16_f32 v155, v158, v159
    buffer_store_dwordx4 v[152:155], v60, s[8:11], s30 offen offset:2176 sc1
    ds_write_b128 v61, v[152:155] offset:6272
    v_mul_f32 v36, 0x3e8293ee, v28
    v_mul_f32 v38, 0x3e8293ee, v30
    v_mul_f32 v40, 0x3e8293ee, v32
    v_mul_f32 v42, 0x3e8293ee, v34
    v_pk_fma_f32 v[64:65], v[168:169], v[20:21], v[64:65] op_sel_hi:[1,0,1]
    v_pk_fma_f32 v[66:67], v[170:171], v[20:21], v[66:67] op_sel_hi:[1,0,1]
    v_pk_fma_f32 v[68:69], v[172:173], v[20:21], v[68:69] op_sel_hi:[1,0,1]
    v_pk_fma_f32 v[70:71], v[174:175], v[20:21], v[70:71] op_sel_hi:[1,0,1]
    v_pk_mul_f32 v[64:65], v[64:65], v[36:37] op_sel_hi:[1,0]
    v_pk_mul_f32 v[66:67], v[66:67], v[36:37] op_sel_hi:[1,0]
    v_pk_mul_f32 v[68:69], v[68:69], v[36:37] op_sel_hi:[1,0]
    v_pk_mul_f32 v[70:71], v[70:71], v[36:37] op_sel_hi:[1,0]
    v_cvt_pk_bf16_f32 v64, v64, v65
    v_cvt_pk_bf16_f32 v65, v66, v67
    v_cvt_pk_bf16_f32 v66, v68, v69
    v_cvt_pk_bf16_f32 v67, v70, v71
    ds_write_b128 v62, v[64:67] offset:0
    v_pk_fma_f32 v[72:73], v[168:169], v[22:23], v[72:73] op_sel_hi:[1,0,1]
    v_pk_fma_f32 v[74:75], v[170:171], v[22:23], v[74:75] op_sel_hi:[1,0,1]
    v_pk_fma_f32 v[76:77], v[172:173], v[22:23], v[76:77] op_sel_hi:[1,0,1]
    v_pk_fma_f32 v[78:79], v[174:175], v[22:23], v[78:79] op_sel_hi:[1,0,1]
    v_pk_mul_f32 v[72:73], v[72:73], v[38:39] op_sel_hi:[1,0]
    v_pk_mul_f32 v[74:75], v[74:75], v[38:39] op_sel_hi:[1,0]
    v_pk_mul_f32 v[76:77], v[76:77], v[38:39] op_sel_hi:[1,0]
    v_pk_mul_f32 v[78:79], v[78:79], v[38:39] op_sel_hi:[1,0]
    v_cvt_pk_bf16_f32 v72, v72, v73
    v_cvt_pk_bf16_f32 v73, v74, v75
    v_cvt_pk_bf16_f32 v74, v76, v77
    v_cvt_pk_bf16_f32 v75, v78, v79
    ds_write_b128 v62, v[72:75] offset:256
    v_pk_fma_f32 v[80:81], v[168:169], v[24:25], v[80:81] op_sel_hi:[1,0,1]
    v_pk_fma_f32 v[82:83], v[170:171], v[24:25], v[82:83] op_sel_hi:[1,0,1]
    v_pk_fma_f32 v[84:85], v[172:173], v[24:25], v[84:85] op_sel_hi:[1,0,1]
    v_pk_fma_f32 v[86:87], v[174:175], v[24:25], v[86:87] op_sel_hi:[1,0,1]
    v_pk_mul_f32 v[80:81], v[80:81], v[40:41] op_sel_hi:[1,0]
    v_pk_mul_f32 v[82:83], v[82:83], v[40:41] op_sel_hi:[1,0]
    v_pk_mul_f32 v[84:85], v[84:85], v[40:41] op_sel_hi:[1,0]
    v_pk_mul_f32 v[86:87], v[86:87], v[40:41] op_sel_hi:[1,0]
    v_cvt_pk_bf16_f32 v80, v80, v81
    v_cvt_pk_bf16_f32 v81, v82, v83
    v_cvt_pk_bf16_f32 v82, v84, v85
    v_cvt_pk_bf16_f32 v83, v86, v87
    ds_write_b128 v62, v[80:83] offset:2048
    v_pk_fma_f32 v[88:89], v[168:169], v[26:27], v[88:89] op_sel_hi:[1,0,1]
    v_pk_fma_f32 v[90:91], v[170:171], v[26:27], v[90:91] op_sel_hi:[1,0,1]
    v_pk_fma_f32 v[92:93], v[172:173], v[26:27], v[92:93] op_sel_hi:[1,0,1]
    v_pk_fma_f32 v[94:95], v[174:175], v[26:27], v[94:95] op_sel_hi:[1,0,1]
    v_pk_mul_f32 v[88:89], v[88:89], v[42:43] op_sel_hi:[1,0]
    v_pk_mul_f32 v[90:91], v[90:91], v[42:43] op_sel_hi:[1,0]
    v_pk_mul_f32 v[92:93], v[92:93], v[42:43] op_sel_hi:[1,0]
    v_pk_mul_f32 v[94:95], v[94:95], v[42:43] op_sel_hi:[1,0]
    v_cvt_pk_bf16_f32 v88, v88, v89
    v_cvt_pk_bf16_f32 v89, v90, v91
    v_cvt_pk_bf16_f32 v90, v92, v93
    v_cvt_pk_bf16_f32 v91, v94, v95
    ds_write_b128 v62, v[88:91] offset:2304
    s_setprio 0
    s_waitcnt lgkmcnt(0)
L_qkv_done:
    s_barrier
    s_cmp_ge_u32 s22, 4
    s_cbranch_scc1 L_qkv_nf
    s_lshl_b32 s29, s21, 2
    s_add_u32 s29, s29, s22
    s_lshl_b32 s27, s29, 9
    s_lshl_b32 s28, s20, 4
    s_add_u32 s27, s27, s28
    s_add_u32 s27, s27, 0x1900000
    v_mov_b32 v4, 0
    v_mov_b32 v5, s78
    s_waitcnt vmcnt(0)
    s_mov_b64 exec, 1
    buffer_store_dword v5, v4, s[8:11], s27 offen sc1
    s_mov_b64 exec, -1
L_qkv_nf:
    s_lshr_b32 s45, s22, 2
    s_and_b32 s46, s22, 3
    s_lshl_b32 s47, s21, 1
    s_add_u32 s47, s47, s45
    s_lshl_b32 s27, s22, 11
    s_add_u32 s27, s27, 131072
    v_add_u32 v60, s27, v2
    ds_read_b128 v[4:7], v60
    ds_read_b128 v[8:11], v60 offset:1024
    s_xor_b32 s27, s45, 1
    s_lshl_b32 s27, s27, 16
    v_add_u32 v61, s27, v2
    v_mov_b32 v62, v61
    v_mov_b32 v63, v61
    ds_read_b128 v[112:115], v62 offset:0
    ds_read_b128 v[116:119], v62 offset:1024
    ds_read_b128 v[120:123], v62 offset:4096
    ds_read_b128 v[124:127], v62 offset:5120
    s_mul_i32 s30, s46, 229376
    s_lshl_b32 s31, s51, 11
    s_add_u32 s30, s30, s31
    s_add_u32 s30, s30, 0x100000
    s_lshl_b32 s31, s46, 12
    s_mov_b32 s34, 1
    s_mov_b32 s35, 16384
    s_add_u32 s33, s31, 65536
    s_mov_b32 s41, 0x2000000
    s_cmp_lt_u32 s22, 4
    s_cbranch_scc1 L_at_nodma
    s_and_b32 s42, s20, 8
    s_add_u32 s42, s42, 8
    s_and_b32 s43, s20, 7
    s_add_u32 s43, s43, 8
    s_lshl_b32 s29, s21, 2
    s_lshr_b32 s27, s46, 1
    s_add_u32 s29, s29, s27
    s_lshl_b32 s44, s29, 9
    s_add_u32 s44, s44, 0x1900000
    v_subrev_u32 v56, s42, v1
    v_and_b32 v56, 15, v56
    v_cmp_gt_u32 vcc, 4, v56
    s_mov_b64 exec, vcc
    v_and_b32 v56, 15, v1
    v_lshlrev_b32 v56, 4, v56
    v_bfe_u32 v57, v1, 4, 1
    v_mul_u32_u24 v57, 1024, v57
    v_add_u32 v56, v56, v57
    s_mov_b32 s27, 0
L_poll_16:
    buffer_load_dword v57, v56, s[8:11], s44 offen sc1
    s_add_u32 s27, s27, 1
    s_waitcnt vmcnt(0)
    v_cmp_ne_u32 vcc, s78, v57
    s_cbranch_vccz L_pd_17
    s_sleep 1
    s_cmp_lt_u32 s27, 0x40000
    s_cbranch_scc1 L_poll_16
L_pd_17:
    s_mov_b64 exec, -1
    s_add_u32 s27, s42, 0
    s_and_b32 s27, s27, 15
    s_mul_i32 s27, s27, 917504
    s_add_u32 s38, s27, s30
    s_add_u32 s38, s38, 4096
    s_add_u32 m0, s31, 16384
    s_nop 0
    buffer_load_dwordx4 v2, s[8:11], s38 offen offset:0 sc1 lds
    buffer_load_dwordx4 v2, s[8:11], s38 offen offset:1024 sc1 lds
    buffer_load_dwordx4 v2, s[8:11], s38 offen offset:2048 sc1 lds
    buffer_load_dwordx4 v2, s[8:11], s38 offen offset:3072 sc1 lds
    s_add_u32 s27, s42, 1
    s_and_b32 s27, s27, 15
    s_mul_i32 s27, s27, 917504
    s_add_u32 s38, s27, s30
    s_add_u32 s38, s38, 4096
    s_add_u32 m0, s31, 32768
    s_nop 0
    buffer_load_dwordx4 v2, s[8:11], s38 offen offset:0 sc1 lds
    buffer_load_dwordx4 v2, s[8:11], s38 offen offset:1024 sc1 lds
    buffer_load_dwordx4 v2, s[8:11], s38 offen offset:2048 sc1 lds
    buffer_load_dwordx4 v2, s[8:11], s38 offen offset:3072 sc1 lds
    s_add_u32 s27, s42, 2
    s_and_b32 s27, s27, 15
    s_mul_i32 s27, s27, 917504
    s_add_u32 s38, s27, s30
    s_add_u32 s38, s38, 4096
    s_add_u32 m0, s31, 49152
    s_nop 0
    buffer_load_dwordx4 v2, s[8:11], s38 offen offset:0 sc1 lds
    buffer_load_dwordx4 v2, s[8:11], s38 offen offset:1024 sc1 lds
    buffer_load_dwordx4 v2, s[8:11], s38 offen offset:2048 sc1 lds
    buffer_load_dwordx4 v2, s[8:11], s38 offen offset:3072 sc1 lds
L_at_nodma:
    s_mov_b32 s40, 0x3ffe
    s_cmp_ge_u32 s22, 4
    s_cselect_b32 s40, 0x6006, s40
    s_cselect_b32 s27, 0x4006, 0
    s_cmp_eq_u32 s23, 0
    s_cselect_b32 s40, s40, s27
    v_bfe_u32 v57, v1, 2, 1
    v_cmp_eq_u32 vcc, 0, v57
    v_mov_b32 v58, 0x3f803f80
    v_and_b32 v56, 1, v1
    v_cndmask_b32 v48, 0, v58, vcc
    v_cndmask_b32 v49, 0, v58, vcc
    v_xor_b32 v50, v58, v48
    v_xor_b32 v51, v58, v49
    v_sub_u32 v56, 0, v56
    v_and_b32 v56, 0xaaaaaaaa, v56
    v_or_b32 v52, 0x44444444, v56
    v_mov_b32 v32, 0
    v_mov_b32 v33, 0
    v_mov_b32 v34, 0
    v_mov_b32 v35, 0
    v_mov_b32 v36, 0
    v_mov_b32 v37, 0
    v_mov_b32 v38, 0
    v_mov_b32 v39, 0
    v_mov_b32 v40, 0
    v_mov_b32 v41, 0
    v_mov_b32 v42, 0
    v_mov_b32 v43, 0
    v_mov_b32 v44, 0
    v_mov_b32 v45, 0
    v_mov_b32 v46, 0
    v_mov_b32 v47, 0
    v_mov_b32 v12, 0
    v_mov_b32 v13, 0
    v_mov_b32 v14, 0
    v_mov_b32 v15, 0
    s_waitcnt lgkmcnt(2)
    v_mfma_f32_32x32x16_bf16 v[80:95], v[112:115], v[4:7], 0
    v_mfma_f32_32x32x16_bf16 v[80:95], v[116:119], v[8:11], v[80:95]
    s_nop 15
    v_max3_f32 v56, v80, v81, v82
    v_max3_f32 v56, v56, v83, v84
    v_max3_f32 v56, v56, v85, v86
    v_max3_f32 v56, v56, v87, v88
    v_max3_f32 v56, v56, v89, v90
    v_max3_f32 v56, v56, v91, v92
    v_max3_f32 v56, v56, v93, v94
    v_max_f32 v56, v56, v95
    v_mov_b32 v57, v56
    s_nop 1
    v_permlane32_swap_b32 v56, v57
    v_max_f32 v56, v56, v57
    v_sub_f32 v16, 0, v56
    v_sub_f32 v17, 0, v56
    v_sub_f32 v18, 0, v56
    v_sub_f32 v19, 0, v56
    v_sub_f32 v20, 0, v56
    v_sub_f32 v21, 0, v56
    v_sub_f32 v22, 0, v56
    v_sub_f32 v23, 0, v56
    v_sub_f32 v24, 0, v56
    v_sub_f32 v25, 0, v56
    v_sub_f32 v26, 0, v56
    v_sub_f32 v27, 0, v56
    v_sub_f32 v28, 0, v56
    v_sub_f32 v29, 0, v56
    v_sub_f32 v30, 0, v56
    v_sub_f32 v31, 0, v56
    s_nop 1
    v_mfma_f32_32x32x16_bf16 v[64:79], v[112:115], v[4:7], v[16:31]
    v_mfma_f32_32x32x16_bf16 v[64:79], v[116:119], v[8:11], v[64:79]
    s_waitcnt lgkmcnt(0)
    s_nop 10
    v_mfma_f32_32x32x16_bf16 v[80:95], v[120:123], v[4:7], v[16:31]
    ds_read_b128 v[112:115], v62 offset:8192
    v_exp_f32 v200, v64
    v_exp_f32 v201, v65
    v_exp_f32 v202, v66
    v_mfma_f32_32x32x16_bf16 v[80:95], v[124:127], v[8:11], v[80:95]
    ds_read_b128 v[116:119], v62 offset:9216
    v_exp_f32 v203, v67
    v_exp_f32 v204, v68
    v_cvt_pk_bf16_f32 v96, v200, v201
    v_exp_f32 v205, v69
    v_exp_f32 v206, v70
    s_waitcnt lgkmcnt(2)
    ds_read_b128 v[128:131], v63 offset:2048
    v_cvt_pk_bf16_f32 v97, v202, v203
    v_exp_f32 v207, v71
    v_exp_f32 v208, v72
    v_cvt_pk_bf16_f32 v98, v204, v205
    v_exp_f32 v209, v73
    ds_read_b128 v[132:135], v63 offset:3072
    v_exp_f32 v210, v74
    v_cvt_pk_bf16_f32 v99, v206, v207
    v_exp_f32 v211, v75
    v_exp_f32 v212, v76
    v_cvt_pk_bf16_f32 v100, v208, v209
    v_exp_f32 v213, v77
    v_exp_f32 v214, v78
    v_cvt_pk_bf16_f32 v101, v210, v211
    v_exp_f32 v215, v79
    s_waitcnt lgkmcnt(2)
    v_mfma_f32_32x32x16_bf16 v[64:79], v[112:115], v[4:7], v[16:31]
    ds_read_b128 v[120:123], v62 offset:12288
    v_exp_f32 v200, v80
    v_cvt_pk_bf16_f32 v102, v212, v213
    v_exp_f32 v201, v81
    v_exp_f32 v202, v82
    v_cvt_pk_bf16_f32 v103, v214, v215
    v_mfma_f32_32x32x16_bf16 v[64:79], v[116:119], v[8:11], v[64:79]
    ds_read_b128 v[124:127], v62 offset:13312
    v_exp_f32 v203, v83
    v_exp_f32 v204, v84
    v_cvt_pk_bf16_f32 v104, v200, v201
    v_exp_f32 v205, v85
    v_exp_f32 v206, v86
    s_waitcnt lgkmcnt(2)
    v_mfma_f32_32x32x16_bf16 v[32:47], v[128:131], v[96:99], v[32:47]
    ds_read_b128 v[136:139], v63 offset:6144
    v_cvt_pk_bf16_f32 v105, v202, v203
    v_exp_f32 v207, v87
    v_exp_f32 v208, v88
    v_cvt_pk_bf16_f32 v106, v204, v205
    v_exp_f32 v209, v89
    v_mfma_f32_32x32x16_bf16 v[32:47], v[132:135], v[100:103], v[32:47]
    ds_read_b128 v[140:143], v63 offset:7168
    v_exp_f32 v210, v90
    v_cvt_pk_bf16_f32 v107, v206, v207
    v_exp_f32 v211, v91
    v_exp_f32 v212, v92
    v_cvt_pk_bf16_f32 v108, v208, v209
    v_smfmac_f32_16x16x64_bf16 v[12:15], v[48:51], v[96:103], v52
    v_exp_f32 v213, v93
    v_exp_f32 v214, v94
    v_cvt_pk_bf16_f32 v109, v210, v211
    v_exp_f32 v215, v95
    s_waitcnt lgkmcnt(2)
    v_mfma_f32_32x32x16_bf16 v[80:95], v[120:123], v[4:7], v[16:31]
    v_exp_f32 v200, v64
    v_cvt_pk_bf16_f32 v110, v212, v213
    v_exp_f32 v201, v65
    v_exp_f32 v202, v66
    v_cvt_pk_bf16_f32 v111, v214, v215
    v_mfma_f32_32x32x16_bf16 v[80:95], v[124:127], v[8:11], v[80:95]
    v_exp_f32 v203, v67
    v_exp_f32 v204, v68
    v_cvt_pk_bf16_f32 v96, v200, v201
    v_exp_f32 v205, v69
    v_exp_f32 v206, v70
    s_waitcnt lgkmcnt(0)
    v_mfma_f32_32x32x16_bf16 v[32:47], v[136:139], v[104:107], v[32:47]
    ds_read_b128 v[128:131], v63 offset:10240
    v_cvt_pk_bf16_f32 v97, v202, v203
    v_exp_f32 v207, v71
    v_exp_f32 v208, v72
    v_cvt_pk_bf16_f32 v98, v204, v205
    v_exp_f32 v209, v73
    v_mfma_f32_32x32x16_bf16 v[32:47], v[140:143], v[108:111], v[32:47]
    ds_read_b128 v[132:135], v63 offset:11264
    v_exp_f32 v210, v74
    v_cvt_pk_bf16_f32 v99, v206, v207
    v_exp_f32 v211, v75
    v_exp_f32 v212, v76
    v_cvt_pk_bf16_f32 v100, v208, v209
    v_smfmac_f32_16x16x64_bf16 v[12:15], v[48:51], v[104:111], v52
    v_exp_f32 v213, v77
    v_exp_f32 v214, v78
    v_cvt_pk_bf16_f32 v101, v210, v211
    v_exp_f32 v215, v79
    s_waitcnt lgkmcnt(2)
    v_exp_f32 v200, v80
    v_cvt_pk_bf16_f32 v102, v212, v213
    v_exp_f32 v201, v81
    v_exp_f32 v202, v82
    v_cvt_pk_bf16_f32 v103, v214, v215
    v_exp_f32 v203, v83
    v_exp_f32 v204, v84
    v_cvt_pk_bf16_f32 v104, v200, v201
    v_exp_f32 v205, v85
    v_exp_f32 v206, v86
    s_waitcnt lgkmcnt(0)
    v_mfma_f32_32x32x16_bf16 v[32:47], v[128:131], v[96:99], v[32:47]
    ds_read_b128 v[136:139], v63 offset:14336
    v_cvt_pk_bf16_f32 v105, v202, v203
    v_exp_f32 v207, v87
    v_exp_f32 v208, v88
    v_cvt_pk_bf16_f32 v106, v204, v205
    v_exp_f32 v209, v89
    v_mfma_f32_32x32x16_bf16 v[32:47], v[132:135], v[100:103], v[32:47]
    ds_read_b128 v[140:143], v63 offset:15360
    v_exp_f32 v210, v90
    v_cvt_pk_bf16_f32 v107, v206, v207
    v_exp_f32 v211, v91
    v_exp_f32 v212, v92
    v_cvt_pk_bf16_f32 v108, v208, v209
    v_smfmac_f32_16x16x64_bf16 v[12:15], v[48:51], v[96:103], v52
    v_exp_f32 v213, v93
    v_exp_f32 v214, v94
    v_cvt_pk_bf16_f32 v109, v210, v211
    v_exp_f32 v215, v95
    s_waitcnt lgkmcnt(2)
    s_waitcnt vmcnt(8) lgkmcnt(0)
    s_barrier
    s_cmp_ge_u32 s22, 4
    s_cbranch_scc1 L_at_preD
    s_barrier
    s_cmp_eq_u32 s23, 0
    s_cbranch_scc0 L_sd_18
    s_lshl_b32 s41, s20, 3
    s_add_u32 s41, s41, s22
    s_mul_i32 s42, s20, 28
    s_add_u32 s42, s42, s22
    s_lshr_b32 s29, s21, 3
    s_lshl_b32 s43, s41, 10
    s_lshl_b32 s28, s29, 17
    s_add_u32 s43, s43, s28
    s_add_u32 s43, s43, 0x100000
    s_lshl_b32 s44, s42, 10
    s_mul_i32 s28, s29, 458752
    s_add_u32 s44, s44, s28
    s_add_u32 s44, s44, 0x200000
    s_lshl_b32 s41, s41, 14
    s_lshl_b32 s42, s42, 14
    s_mul_i32 s39, s20, 458752
    s_cmp_eq_u32 s22, 3
    s_cbranch_scc1 L_w1_19
    v_lshrrev_b32 v56, 3, v1
    v_and_b32 v57, 0x70, v2
    s_lshl_b32 s27, s51, 6
    s_lshl_b32 s28, s22, 7
    s_add_u32 s27, s27, s28
    s_mov_b32 s38, 57344
    s_mov_b32 s33, 0
    s_branch L_w1_20
L_w1_19:
    v_lshrrev_b32 v56, 2, v1
    v_and_b32 v57, 0x30, v2
    s_lshl_b32 s27, s50, 6
    s_mov_b32 s38, 114688
    s_mov_b32 s33, 0x800000
L_w1_20:
    v_mul_u32_u24 v56, 7168, v56
    v_add3_u32 v198, v56, v57, s27
    buffer_load_dwordx4 v[152:155], v198, s[56:59], s39 offen
    s_add_u32 s39, s39, s38
    buffer_load_dwordx4 v[156:159], v198, s[56:59], s39 offen
    s_add_u32 s39, s39, s38
    buffer_load_dwordx4 v[160:163], v198, s[56:59], s39 offen
    s_add_u32 s39, s39, s38
    buffer_load_dwordx4 v[164:167], v198, s[56:59], s39 offen
    s_add_u32 s39, s39, s38
L_sd_18:
    s_barrier
    s_cmp_eq_u32 s23, 0
    s_cbranch_scc0 L_sd_21
    s_add_u32 s39, s39, s33
    buffer_load_dwordx4 v[168:171], v198, s[56:59], s39 offen
    s_add_u32 s39, s39, s38
    buffer_load_dwordx4 v[172:175], v198, s[56:59], s39 offen
    s_add_u32 s39, s39, s38
    buffer_load_dwordx4 v[176:179], v198, s[56:59], s39 offen
    s_add_u32 s39, s39, s38
    buffer_load_dwordx4 v[180:183], v198, s[56:59], s39 offen
    s_add_u32 s39, s39, s38
L_sd_21:
    s_barrier
    s_cmp_eq_u32 s23, 0
    s_cbranch_scc0 L_sd_22
L_sd_22:
    v_add_u32 v62, s35, v61
    v_add_u32 v63, s35, v61
    ds_read_b128 v[112:115], v62 offset:0
    ds_read_b128 v[116:119], v62 offset:1024
    ds_read_b128 v[120:123], v62 offset:4096
    ds_read_b128 v[124:127], v62 offset:5120
    s_waitcnt lgkmcnt(2)
    v_mfma_f32_32x32x16_bf16 v[64:79], v[112:115], v[4:7], v[16:31]
    v_mfma_f32_32x32x16_bf16 v[64:79], v[116:119], v[8:11], v[64:79]
    s_waitcnt lgkmcnt(0)
    s_nop 10
L_at_loopS:
    v_mfma_f32_32x32x16_bf16 v[80:95], v[120:123], v[4:7], v[16:31]
    ds_read_b128 v[112:115], v62 offset:8192
    v_exp_f32 v200, v64
    v_cvt_pk_bf16_f32 v110, v212, v213
    v_exp_f32 v201, v65
    v_exp_f32 v202, v66
    v_cvt_pk_bf16_f32 v111, v214, v215
    v_mfma_f32_32x32x16_bf16 v[80:95], v[124:127], v[8:11], v[80:95]
    ds_read_b128 v[116:119], v62 offset:9216
    v_exp_f32 v203, v67
    v_exp_f32 v204, v68
    v_cvt_pk_bf16_f32 v96, v200, v201
    v_exp_f32 v205, v69
    v_exp_f32 v206, v70
    s_waitcnt lgkmcnt(2)
    v_mfma_f32_32x32x16_bf16 v[32:47], v[136:139], v[104:107], v[32:47]
    ds_read_b128 v[128:131], v63 offset:2048
    v_cvt_pk_bf16_f32 v97, v202, v203
    v_exp_f32 v207, v71
    v_exp_f32 v208, v72
    v_cvt_pk_bf16_f32 v98, v204, v205
    v_exp_f32 v209, v73
    v_mfma_f32_32x32x16_bf16 v[32:47], v[140:143], v[108:111], v[32:47]
    ds_read_b128 v[132:135], v63 offset:3072
    v_exp_f32 v210, v74
    v_cvt_pk_bf16_f32 v99, v206, v207
    v_exp_f32 v211, v75
    v_exp_f32 v212, v76
    v_cvt_pk_bf16_f32 v100, v208, v209
    v_smfmac_f32_16x16x64_bf16 v[12:15], v[48:51], v[104:111], v52
    v_exp_f32 v213, v77
    v_exp_f32 v214, v78
    v_cvt_pk_bf16_f32 v101, v210, v211
    v_exp_f32 v215, v79
    s_waitcnt lgkmcnt(2)
    v_mfma_f32_32x32x16_bf16 v[64:79], v[112:115], v[4:7], v[16:31]
    ds_read_b128 v[120:123], v62 offset:12288
    v_exp_f32 v200, v80
    v_cvt_pk_bf16_f32 v102, v212, v213
    v_exp_f32 v201, v81
    v_exp_f32 v202, v82
    v_cvt_pk_bf16_f32 v103, v214, v215
    v_mfma_f32_32x32x16_bf16 v[64:79], v[116:119], v[8:11], v[64:79]
    ds_read_b128 v[124:127], v62 offset:13312
    v_exp_f32 v203, v83
    v_exp_f32 v204, v84
    v_cvt_pk_bf16_f32 v104, v200, v201
    v_exp_f32 v205, v85
    v_exp_f32 v206, v86
    s_waitcnt lgkmcnt(2)
    v_mfma_f32_32x32x16_bf16 v[32:47], v[128:131], v[96:99], v[32:47]
    ds_read_b128 v[136:139], v63 offset:6144
    v_cvt_pk_bf16_f32 v105, v202, v203
    v_exp_f32 v207, v87
    v_exp_f32 v208, v88
    v_cvt_pk_bf16_f32 v106, v204, v205
    v_exp_f32 v209, v89
    v_mfma_f32_32x32x16_bf16 v[32:47], v[132:135], v[100:103], v[32:47]
    ds_read_b128 v[140:143], v63 offset:7168
    v_exp_f32 v210, v90
    v_cvt_pk_bf16_f32 v107, v206, v207
    v_exp_f32 v211, v91
    v_exp_f32 v212, v92
    v_cvt_pk_bf16_f32 v108, v208, v209
    v_smfmac_f32_16x16x64_bf16 v[12:15], v[48:51], v[96:103], v52
    v_exp_f32 v213, v93
    v_exp_f32 v214, v94
    s_add_u32 s35, s35, 16384
    s_and_b32 s35, s35, 0xffff
    v_cvt_pk_bf16_f32 v109, v210, v211
    v_exp_f32 v215, v95
    s_cmp_eq_u32 s34, 15
    s_waitcnt lgkmcnt(2)
    s_cbranch_scc1 L_at_retS
    s_barrier
    s_bitcmp1_b32 s40, s34
    s_cbranch_scc1 L_at_hookS
L_at_retS:
    v_add_u32 v62, s35, v61
    v_mfma_f32_32x32x16_bf16 v[80:95], v[120:123], v[4:7], v[16:31]
    ds_read_b128 v[112:115], v62 offset:0
    v_exp_f32 v200, v64
    v_cvt_pk_bf16_f32 v110, v212, v213
    v_exp_f32 v201, v65
    v_exp_f32 v202, v66
    v_cvt_pk_bf16_f32 v111, v214, v215
    v_mfma_f32_32x32x16_bf16 v[80:95], v[124:127], v[8:11], v[80:95]
    ds_read_b128 v[116:119], v62 offset:1024
    v_exp_f32 v203, v67
    v_exp_f32 v204, v68
    v_cvt_pk_bf16_f32 v96, v200, v201
    v_exp_f32 v205, v69
    v_exp_f32 v206, v70
    s_waitcnt lgkmcnt(2)
    v_mfma_f32_32x32x16_bf16 v[32:47], v[136:139], v[104:107], v[32:47]
    ds_read_b128 v[128:131], v63 offset:10240
    v_cvt_pk_bf16_f32 v97, v202, v203
    v_exp_f32 v207, v71
    v_exp_f32 v208, v72
    v_cvt_pk_bf16_f32 v98, v204, v205
    v_exp_f32 v209, v73
    v_mfma_f32_32x32x16_bf16 v[32:47], v[140:143], v[108:111], v[32:47]
    ds_read_b128 v[132:135], v63 offset:11264
    v_exp_f32 v210, v74
    v_cvt_pk_bf16_f32 v99, v206, v207
    v_exp_f32 v211, v75
    v_exp_f32 v212, v76
    v_cvt_pk_bf16_f32 v100, v208, v209
    v_smfmac_f32_16x16x64_bf16 v[12:15], v[48:51], v[104:111], v52
    v_exp_f32 v213, v77
    v_exp_f32 v214, v78
    v_cvt_pk_bf16_f32 v101, v210, v211
    v_exp_f32 v215, v79
    s_waitcnt lgkmcnt(2)
    v_mfma_f32_32x32x16_bf16 v[64:79], v[112:115], v[4:7], v[16:31]
    ds_read_b128 v[120:123], v62 offset:4096
    v_exp_f32 v200, v80
    v_cvt_pk_bf16_f32 v102, v212, v213
    v_exp_f32 v201, v81
    v_exp_f32 v202, v82
    v_cvt_pk_bf16_f32 v103, v214, v215
    v_mfma_f32_32x32x16_bf16 v[64:79], v[116:119], v[8:11], v[64:79]
    ds_read_b128 v[124:127], v62 offset:5120
    v_exp_f32 v203, v83
    v_exp_f32 v204, v84
    v_cvt_pk_bf16_f32 v104, v200, v201
    v_exp_f32 v205, v85
    v_exp_f32 v206, v86
    s_waitcnt lgkmcnt(2)
    v_mfma_f32_32x32x16_bf16 v[32:47], v[128:131], v[96:99], v[32:47]
    ds_read_b128 v[136:139], v63 offset:14336
    v_cvt_pk_bf16_f32 v105, v202, v203
    v_exp_f32 v207, v87
    v_exp_f32 v208, v88
    v_cvt_pk_bf16_f32 v106, v204, v205
    v_exp_f32 v209, v89
    v_mfma_f32_32x32x16_bf16 v[32:47], v[132:135], v[100:103], v[32:47]
    ds_read_b128 v[140:143], v63 offset:15360
    v_exp_f32 v210, v90
    v_cvt_pk_bf16_f32 v107, v206, v207
    v_exp_f32 v211, v91
    v_exp_f32 v212, v92
    v_cvt_pk_bf16_f32 v108, v208, v209
    v_smfmac_f32_16x16x64_bf16 v[12:15], v[48:51], v[96:103], v52
    v_exp_f32 v213, v93
    s_add_u32 s34, s34, 1
    s_cmp_lt_u32 s34, 16
    v_exp_f32 v214, v94
    v_mov_b32 v63, v62
    v_cvt_pk_bf16_f32 v109, v210, v211
    v_exp_f32 v215, v95
    s_waitcnt lgkmcnt(2)
    s_cbranch_scc1 L_at_loopS
    s_branch L_at_out
L_at_preD:
    s_setprio 1
    v_add_u32 v62, s35, v61
    v_add_u32 v63, s35, v61
    ds_read_b128 v[112:115], v62 offset:0
    ds_read_b128 v[116:119], v62 offset:1024
    ds_read_b128 v[120:123], v62 offset:4096
    ds_read_b128 v[124:127], v62 offset:5120
    s_waitcnt lgkmcnt(2)
    v_mfma_f32_32x32x16_bf16 v[64:79], v[112:115], v[4:7], v[16:31]
    v_mfma_f32_32x32x16_bf16 v[64:79], v[116:119], v[8:11], v[64:79]
    s_waitcnt lgkmcnt(0)
    s_nop 10
L_at_loopD:
    v_mfma_f32_32x32x16_bf16 v[80:95], v[120:123], v[4:7], v[16:31]
    ds_read_b128 v[112:115], v62 offset:8192
    v_exp_f32 v200, v64
    s_mov_b32 m0, s33
    v_cvt_pk_bf16_f32 v110, v212, v213
    v_exp_f32 v201, v65
    v_exp_f32 v202, v66
    v_cvt_pk_bf16_f32 v111, v214, v215
    v_mfma_f32_32x32x16_bf16 v[80:95], v[124:127], v[8:11], v[80:95]
    ds_read_b128 v[116:119], v62 offset:9216
    v_exp_f32 v203, v67
    buffer_load_dwordx4 v2, s[8:11], s41 offen offset:0 sc1 lds
    v_exp_f32 v204, v68
    v_cvt_pk_bf16_f32 v96, v200, v201
    v_exp_f32 v205, v69
    v_exp_f32 v206, v70
    s_waitcnt lgkmcnt(2)
    v_mfma_f32_32x32x16_bf16 v[32:47], v[136:139], v[104:107], v[32:47]
    ds_read_b128 v[128:131], v63 offset:2048
    v_cvt_pk_bf16_f32 v97, v202, v203
    v_exp_f32 v207, v71
    v_exp_f32 v208, v72
    v_cvt_pk_bf16_f32 v98, v204, v205
    v_exp_f32 v209, v73
    buffer_load_dwordx4 v2, s[8:11], s41 offen offset:1024 sc1 lds
    v_mfma_f32_32x32x16_bf16 v[32:47], v[140:143], v[108:111], v[32:47]
    ds_read_b128 v[132:135], v63 offset:3072
    v_exp_f32 v210, v74
    v_cvt_pk_bf16_f32 v99, v206, v207
    v_exp_f32 v211, v75
    v_exp_f32 v212, v76
    v_cvt_pk_bf16_f32 v100, v208, v209
    v_smfmac_f32_16x16x64_bf16 v[12:15], v[48:51], v[104:111], v52
    v_exp_f32 v213, v77
    v_exp_f32 v214, v78
    v_cvt_pk_bf16_f32 v101, v210, v211
    v_exp_f32 v215, v79
    s_waitcnt lgkmcnt(2)
    v_mfma_f32_32x32x16_bf16 v[64:79], v[112:115], v[4:7], v[16:31]
    ds_read_b128 v[120:123], v62 offset:12288
    v_exp_f32 v200, v80
    v_cvt_pk_bf16_f32 v102, v212, v213
    v_exp_f32 v201, v81
    v_exp_f32 v202, v82
    v_cvt_pk_bf16_f32 v103, v214, v215
    v_mfma_f32_32x32x16_bf16 v[64:79], v[116:119], v[8:11], v[64:79]
    ds_read_b128 v[124:127], v62 offset:13312
    v_exp_f32 v203, v83
    buffer_load_dwordx4 v2, s[8:11], s41 offen offset:2048 sc1 lds
    v_exp_f32 v204, v84
    v_cvt_pk_bf16_f32 v104, v200, v201
    v_exp_f32 v205, v85
    s_add_u32 s27, s34, 2
    v_exp_f32 v206, v86
    s_waitcnt lgkmcnt(2)
    v_mfma_f32_32x32x16_bf16 v[32:47], v[128:131], v[96:99], v[32:47]
    ds_read_b128 v[136:139], v63 offset:6144
    v_cvt_pk_bf16_f32 v105, v202, v203
    v_exp_f32 v207, v87
    v_exp_f32 v208, v88
    buffer_load_dwordx4 v2, s[8:11], s41 offen offset:3072 sc1 lds
    v_cvt_pk_bf16_f32 v106, v204, v205
    v_exp_f32 v209, v89
    s_cmp_ge_u32 s27, s43
    s_addc_u32 s27, s27, s42
    v_mfma_f32_32x32x16_bf16 v[32:47], v[132:135], v[100:103], v[32:47]
    ds_read_b128 v[140:143], v63 offset:7168
    v_exp_f32 v210, v90
    s_and_b32 s27, s27, 15
    s_mul_i32 s27, s27, 917504
    v_cvt_pk_bf16_f32 v107, v206, v207
    v_exp_f32 v211, v91
    s_add_u32 s38, s27, s30
    s_add_u32 s38, s38, 4096
    v_exp_f32 v212, v92
    s_cmp_lt_u32 s34, 13
    s_cselect_b32 s38, s38, 0x2000000
    v_cvt_pk_bf16_f32 v108, v208, v209
    v_smfmac_f32_16x16x64_bf16 v[12:15], v[48:51], v[96:103], v52
    v_exp_f32 v213, v93
    s_sub_u32 s39, s35, 16384
    s_and_b32 s39, s39, 0xffff
    v_exp_f32 v214, v94
    s_add_u32 s39, s39, s31
    s_add_u32 s35, s35, 16384
    s_and_b32 s35, s35, 0xffff
    v_cvt_pk_bf16_f32 v109, v210, v211
    v_exp_f32 v215, v95
    s_bitcmp1_b32 s40, s34
    s_waitcnt lgkmcnt(2)
    s_cbranch_scc1 L_at_hookD
    s_waitcnt vmcnt(8)
    s_barrier
L_at_retD:
    v_add_u32 v62, s35, v61
    v_mfma_f32_32x32x16_bf16 v[80:95], v[120:123], v[4:7], v[16:31]
    ds_read_b128 v[112:115], v62 offset:0
    v_exp_f32 v200, v64
    s_mov_b32 m0, s39
    v_cvt_pk_bf16_f32 v110, v212, v213
    v_exp_f32 v201, v65
    s_sub_u32 s27, s34, 1
    v_exp_f32 v202, v66
    v_cvt_pk_bf16_f32 v111, v214, v215
    v_mfma_f32_32x32x16_bf16 v[80:95], v[124:127], v[8:11], v[80:95]
    ds_read_b128 v[116:119], v62 offset:1024
    v_exp_f32 v203, v67
    buffer_load_dwordx4 v2, s[8:11], s38 offen offset:0 sc1 lds
    v_exp_f32 v204, v68
    v_cvt_pk_bf16_f32 v96, v200, v201
    v_exp_f32 v205, v69
    s_cmp_ge_u32 s27, s43
    s_addc_u32 s27, s27, s42
    v_exp_f32 v206, v70
    s_and_b32 s27, s27, 15
    s_waitcnt lgkmcnt(2)
    v_mfma_f32_32x32x16_bf16 v[32:47], v[136:139], v[104:107], v[32:47]
    ds_read_b128 v[128:131], v63 offset:10240
    v_cvt_pk_bf16_f32 v97, v202, v203
    v_exp_f32 v207, v71
    v_exp_f32 v208, v72
    v_cvt_pk_bf16_f32 v98, v204, v205
    v_exp_f32 v209, v73
    buffer_load_dwordx4 v2, s[8:11], s38 offen offset:1024 sc1 lds
    v_mfma_f32_32x32x16_bf16 v[32:47], v[140:143], v[108:111], v[32:47]
    ds_read_b128 v[132:135], v63 offset:11264
    v_exp_f32 v210, v74
    s_mul_i32 s27, s27, 917504
    s_add_u32 s41, s27, s30
    v_cvt_pk_bf16_f32 v99, v206, v207
    v_exp_f32 v211, v75
    v_exp_f32 v212, v76
    s_add_u32 s33, s35, 49152
    s_and_b32 s33, s33, 0xffff
    v_cvt_pk_bf16_f32 v100, v208, v209
    v_smfmac_f32_16x16x64_bf16 v[12:15], v[48:51], v[104:111], v52
    v_exp_f32 v213, v77
    s_add_u32 s33, s33, s31
    s_add_u32 s33, s33, 65536
    v_exp_f32 v214, v78
    v_cvt_pk_bf16_f32 v101, v210, v211
    v_exp_f32 v215, v79
    s_waitcnt lgkmcnt(2)
    v_mfma_f32_32x32x16_bf16 v[64:79], v[112:115], v[4:7], v[16:31]
    ds_read_b128 v[120:123], v62 offset:4096
    v_exp_f32 v200, v80
    v_cvt_pk_bf16_f32 v102, v212, v213
    v_exp_f32 v201, v81
    v_exp_f32 v202, v82
    v_cvt_pk_bf16_f32 v103, v214, v215
    v_mfma_f32_32x32x16_bf16 v[64:79], v[116:119], v[8:11], v[64:79]
    ds_read_b128 v[124:127], v62 offset:5120
    v_exp_f32 v203, v83
    buffer_load_dwordx4 v2, s[8:11], s38 offen offset:2048 sc1 lds
    v_exp_f32 v204, v84
    v_cvt_pk_bf16_f32 v104, v200, v201
    v_exp_f32 v205, v85
    v_exp_f32 v206, v86
    s_waitcnt lgkmcnt(2)
    v_mfma_f32_32x32x16_bf16 v[32:47], v[128:131], v[96:99], v[32:47]
    ds_read_b128 v[136:139], v63 offset:14336
    v_cvt_pk_bf16_f32 v105, v202, v203
    v_exp_f32 v207, v87
    v_exp_f32 v208, v88
    v_cvt_pk_bf16_f32 v106, v204, v205
    v_exp_f32 v209, v89
    buffer_load_dwordx4 v2, s[8:11], s38 offen offset:3072 sc1 lds
    v_mfma_f32_32x32x16_bf16 v[32:47], v[132:135], v[100:103], v[32:47]
    ds_read_b128 v[140:143], v63 offset:15360
    v_exp_f32 v210, v90
    v_cvt_pk_bf16_f32 v107, v206, v207
    v_exp_f32 v211, v91
    v_exp_f32 v212, v92
    v_cvt_pk_bf16_f32 v108, v208, v209
    v_smfmac_f32_16x16x64_bf16 v[12:15], v[48:51], v[96:103], v52
    v_exp_f32 v213, v93
    s_add_u32 s34, s34, 1
    s_cmp_lt_u32 s34, 16
    v_exp_f32 v214, v94
    v_mov_b32 v63, v62
    v_cvt_pk_bf16_f32 v109, v210, v211
    v_exp_f32 v215, v95
    s_waitcnt lgkmcnt(2)
    s_cbranch_scc1 L_at_loopD
    s_cmp_le_u32 s43, 14
    s_addc_u32 s27, s42, 14
    s_and_b32 s27, s27, 15
    s_mul_i32 s27, s27, 917504
    s_add_u32 s41, s27, s30
    s_add_u32 m0, s31, 114688
    s_nop 0
    buffer_load_dwordx4 v2, s[8:11], s41 offen offset:0 sc1 lds
    buffer_load_dwordx4 v2, s[8:11], s41 offen offset:1024 sc1 lds
    buffer_load_dwordx4 v2, s[8:11], s41 offen offset:2048 sc1 lds
    buffer_load_dwordx4 v2, s[8:11], s41 offen offset:3072 sc1 lds
L_at_out:
    s_nop 0
    v_cvt_pk_bf16_f32 v110, v212, v213
    v_cvt_pk_bf16_f32 v111, v214, v215
    s_waitcnt lgkmcnt(0)
    s_nop 0
    v_mfma_f32_32x32x16_bf16 v[32:47], v[136:139], v[104:107], v[32:47]
    v_mfma_f32_32x32x16_bf16 v[32:47], v[140:143], v[108:111], v[32:47]
    v_smfmac_f32_16x16x64_bf16 v[12:15], v[48:51], v[104:111], v52
    s_nop 15
    v_max3_f32 v56, |v32|, |v33|, |v34|
    v_max3_f32 v56, v56, |v35|, |v36|
    v_max3_f32 v56, v56, |v37|, |v38|
    v_max3_f32 v56, v56, |v39|, |v40|
    v_max3_f32 v56, v56, |v41|, |v42|
    v_max3_f32 v56, v56, |v43|, |v44|
    v_max3_f32 v56, v56, |v45|, |v46|
    v_max_f32 v56, v56, |v47|
    v_mov_b32 v57, 0x5d800000
    v_mov_b32 v58, 0x7f800000
    v_add_f32 v12, v12, v13
    v_cmp_nlt_f32 vcc, v12, v57
    v_cmp_nlt_f32 s[36:37], v56, v58
    s_or_b64 vcc, vcc, s[36:37]
    s_cbranch_vccnz L_at_slow
L_at_fin:
    v_rcp_f32 v56, v12
    s_mul_i32 s26, s3, 229376
    s_add_u32 s27, s51, s45
    s_lshl_b32 s27, s27, 11
    s_add_u32 s26, s26, s27
    s_add_u32 s26, s26, 0x102000
    v_pk_mul_f32 v[32:33], v[32:33], v[56:57] op_sel_hi:[1,0]
    v_pk_mul_f32 v[34:35], v[34:35], v[56:57] op_sel_hi:[1,0]
    v_pk_mul_f32 v[36:37], v[36:37], v[56:57] op_sel_hi:[1,0]
    v_pk_mul_f32 v[38:39], v[38:39], v[56:57] op_sel_hi:[1,0]
    v_pk_mul_f32 v[40:41], v[40:41], v[56:57] op_sel_hi:[1,0]
    v_pk_mul_f32 v[42:43], v[42:43], v[56:57] op_sel_hi:[1,0]
    v_pk_mul_f32 v[44:45], v[44:45], v[56:57] op_sel_hi:[1,0]
    v_pk_mul_f32 v[46:47], v[46:47], v[56:57] op_sel_hi:[1,0]
    v_bfe_u32 v57, v1, 4, 1
    v_lshlrev_b32 v57, 10, v57
    v_lshrrev_b32 v58, 5, v1
    v_lshlrev_b32 v58, 8, v58
    v_and_b32 v59, 0xf0, v2
    v_add3_u32 v57, v57, v58, v59
    v_cvt_pk_bf16_f32 v32, v32, v33
    v_cvt_pk_bf16_f32 v33, v34, v35
    v_cvt_pk_bf16_f32 v34, v36, v37
    v_cvt_pk_bf16_f32 v35, v38, v39
    v_cvt_pk_bf16_f32 v36, v40, v41
    v_cvt_pk_bf16_f32 v37, v42, v43
    v_cvt_pk_bf16_f32 v38, v44, v45
    v_cvt_pk_bf16_f32 v39, v46, v47
    buffer_store_dwordx4 v[32:35], v57, s[8:11], s26 offen sc1
    buffer_store_dwordx4 v[36:39], v57, s[8:11], s26 offen offset:512 sc1
    s_cmp_lt_u32 s22, 4
    s_cbranch_scc1 L_wo_cons
    s_setprio 0
    s_waitcnt vmcnt(10)
    s_barrier
    s_lshl_b32 s27, s3, 9
    s_lshl_b32 s28, s21, 4
    s_add_u32 s27, s27, s28
    s_add_u32 s27, s27, 0x1940000
    v_mov_b32 v4, 0
    v_mov_b32 v5, s78
    s_waitcnt vmcnt(0)
    s_mov_b64 exec, 1
    buffer_store_dword v5, v4, s[8:11], s27 offen sc1
    s_mov_b64 exec, -1
    s_barrier
    s_cmp_ge_u32 s22, 4
    s_cbranch_scc0 L_wo_cons
    s_sub_u32 s26, s22, 4
    s_lshl_b32 s24, s20, 2
    s_add_u32 s24, s24, s26
    s_lshl_b32 s38, s26, 12
    s_lshl_b32 s39, s26, 11
    s_lshl_b32 s40, s26, 10
    s_mul_i32 s27, s24, 229376
    s_add_u32 s27, s27, 0x102000
    v_add_u32 v192, s27, v2
    v_add_u32 v197, 14336, v192
    s_mov_b32 s37, 49152
    s_mov_b32 s36, 13
    s_lshl_b32 s43, s24, 9
    s_add_u32 s43, s43, 0x1940000
    s_mov_b32 s35, 2048
    v_and_b32 v8, 15, v1
    v_lshlrev_b32 v8, 4, v8
    s_mov_b32 s27, 0
L_poll_23:
    buffer_load_dword v9, v8, s[8:11], s43 offen sc1
    s_add_u32 s27, s27, 1
    s_waitcnt vmcnt(0)
    v_cmp_ne_u32 vcc, s78, v9
    s_cbranch_vccz L_pd_24
    s_sleep 1
    s_cmp_lt_u32 s27, 0x40000
    s_cbranch_scc1 L_poll_23
L_pd_24:
    s_add_u32 m0, s38, 0
    s_nop 0
    buffer_load_dwordx4 v192, s[8:11], s35 offen offset:0 sc1 lds
    buffer_load_dwordx4 v192, s[8:11], s35 offen offset:1024 sc1 lds
    buffer_load_dwordx4 v197, s[8:11], s35 offen offset:2048 sc1 lds
    buffer_load_dwordx4 v197, s[8:11], s35 offen offset:3072 sc1 lds
    s_add_u32 s35, s35, 28672
    s_add_u32 m0, s38, 16384
    s_nop 0
    buffer_load_dwordx4 v192, s[8:11], s35 offen offset:0 sc1 lds
    buffer_load_dwordx4 v192, s[8:11], s35 offen offset:1024 sc1 lds
    buffer_load_dwordx4 v197, s[8:11], s35 offen offset:2048 sc1 lds
    buffer_load_dwordx4 v197, s[8:11], s35 offen offset:3072 sc1 lds
    s_add_u32 s35, s35, 28672
    s_add_u32 m0, s38, 32768
    s_nop 0
    buffer_load_dwordx4 v192, s[8:11], s35 offen offset:0 sc1 lds
    buffer_load_dwordx4 v192, s[8:11], s35 offen offset:1024 sc1 lds
    buffer_load_dwordx4 v197, s[8:11], s35 offen offset:2048 sc1 lds
    buffer_load_dwordx4 v197, s[8:11], s35 offen offset:3072 sc1 lds
    s_add_u32 s35, s35, 28672
    s_waitcnt vmcnt(8)
    s_barrier
    s_lshr_b32 s35, s36, 2
    s_mul_i32 s35, s35, 14
    s_and_b32 s27, s36, 1
    s_add_u32 s35, s35, s27
    s_lshl_b32 s35, s35, 11
    s_add_u32 s33, s37, s38
    s_add_u32 m0, s33, 0
    s_nop 0
    buffer_load_dwordx4 v192, s[8:11], s35 offen offset:0 sc1 lds
    buffer_load_dwordx4 v192, s[8:11], s35 offen offset:1024 sc1 lds
    buffer_load_dwordx4 v197, s[8:11], s35 offen offset:2048 sc1 lds
    buffer_load_dwordx4 v197, s[8:11], s35 offen offset:3072 sc1 lds
    s_add_u32 s37, s37, 16384
    s_and_b32 s37, s37, 0xffff
    s_lshr_b32 s33, s37, 1
    s_add_u32 s33, s33, s39
    s_add_u32 m0, s33, 122880
    s_lshl_b32 s27, s36, s44
    buffer_load_dwordx4 v193, s[12:15], s27 offen sc1 lds
    buffer_load_dwordx4 v194, s[12:15], s27 offen offset:1024 sc1 lds
    s_add_u32 s36, s36, 4
    s_cmp_eq_u32 s36, 33
    s_cselect_b32 s36, 0, s36
    s_waitcnt vmcnt(10)
    s_barrier
    s_lshr_b32 s35, s36, 2
    s_mul_i32 s35, s35, 14
    s_and_b32 s27, s36, 1
    s_add_u32 s35, s35, s27
    s_lshl_b32 s35, s35, 11
    s_add_u32 s33, s37, s38
    s_add_u32 m0, s33, 0
    s_nop 0
    buffer_load_dwordx4 v192, s[8:11], s35 offen offset:0 sc1 lds
    buffer_load_dwordx4 v192, s[8:11], s35 offen offset:1024 sc1 lds
    buffer_load_dwordx4 v197, s[8:11], s35 offen offset:2048 sc1 lds
    buffer_load_dwordx4 v197, s[8:11], s35 offen offset:3072 sc1 lds
    s_add_u32 s37, s37, 16384
    s_and_b32 s37, s37, 0xffff
    s_lshr_b32 s33, s37, 1
    s_add_u32 s33, s33, s39
    s_add_u32 m0, s33, 122880
    s_lshl_b32 s27, s36, s44
    buffer_load_dwordx4 v193, s[12:15], s27 offen sc1 lds
    buffer_load_dwordx4 v194, s[12:15], s27 offen offset:1024 sc1 lds
    s_add_u32 s36, s36, 4
    s_cmp_eq_u32 s36, 33
    s_cselect_b32 s36, 0, s36
    s_waitcnt vmcnt(12)
    s_barrier
    s_lshr_b32 s35, s36, 2
    s_mul_i32 s35, s35, 14
    s_and_b32 s27, s36, 1
    s_add_u32 s35, s35, s27
    s_lshl_b32 s35, s35, 11
    s_add_u32 s33, s37, s38
    s_add_u32 m0, s33, 0
    s_nop 0
    buffer_load_dwordx4 v192, s[8:11], s35 offen offset:0 sc1 lds
    buffer_load_dwordx4 v192, s[8:11], s35 offen offset:1024 sc1 lds
    buffer_load_dwordx4 v197, s[8:11], s35 offen offset:2048 sc1 lds
    buffer_load_dwordx4 v197, s[8:11], s35 offen offset:3072 sc1 lds
    s_add_u32 s37, s37, 16384
    s_and_b32 s37, s37, 0xffff
    s_lshr_b32 s33, s37, 1
    s_add_u32 s33, s33, s39
    s_add_u32 m0, s33, 122880
    s_lshl_b32 s27, s36, s44
    buffer_load_dwordx4 v193, s[12:15], s27 offen sc1 lds
    buffer_load_dwordx4 v194, s[12:15], s27 offen offset:1024 sc1 lds
    s_add_u32 s36, s36, 4
    s_cmp_eq_u32 s36, 33
    s_cselect_b32 s36, 0, s36
    s_waitcnt vmcnt(12)
    s_barrier
    s_lshr_b32 s35, s36, 2
    s_mul_i32 s35, s35, 14
    s_and_b32 s27, s36, 1
    s_add_u32 s35, s35, s27
    s_lshl_b32 s35, s35, 11
    s_add_u32 s33, s37, s38
    s_add_u32 m0, s33, 0
    s_nop 0
    buffer_load_dwordx4 v192, s[8:11], s35 offen offset:0 sc1 lds
    buffer_load_dwordx4 v192, s[8:11], s35 offen offset:1024 sc1 lds
    buffer_load_dwordx4 v197, s[8:11], s35 offen offset:2048 sc1 lds
    buffer_load_dwordx4 v197, s[8:11], s35 offen offset:3072 sc1 lds
    s_add_u32 s37, s37, 16384
    s_and_b32 s37, s37, 0xffff
    s_lshr_b32 s33, s37, 1
    s_add_u32 s33, s33, s39
    s_add_u32 m0, s33, 122880
    s_lshl_b32 s27, s36, s44
    buffer_load_dwordx4 v193, s[12:15], s27 offen sc1 lds
    buffer_load_dwordx4 v194, s[12:15], s27 offen offset:1024 sc1 lds
    s_add_u32 s36, s36, 4
    s_cmp_eq_u32 s36, 33
    s_cselect_b32 s36, 0, s36
    s_waitcnt vmcnt(12)
    s_barrier
    v_and_b32 v8, 31, v1
    v_lshlrev_b32 v8, 4, v8
    buffer_load_dword v16, v8, s[8:11], s43 offen sc1
    s_lshr_b32 s35, s36, 2
    s_mul_i32 s35, s35, 14
    s_and_b32 s27, s36, 1
    s_add_u32 s35, s35, s27
    s_lshl_b32 s35, s35, 11
    s_add_u32 s33, s37, s38
    s_add_u32 m0, s33, 0
    s_nop 0
    buffer_load_dwordx4 v192, s[8:11], s35 offen offset:0 sc1 lds
    buffer_load_dwordx4 v192, s[8:11], s35 offen offset:1024 sc1 lds
    buffer_load_dwordx4 v197, s[8:11], s35 offen offset:2048 sc1 lds
    buffer_load_dwordx4 v197, s[8:11], s35 offen offset:3072 sc1 lds
    s_add_u32 s37, s37, 16384
    s_and_b32 s37, s37, 0xffff
    s_lshr_b32 s33, s37, 1
    s_add_u32 s33, s33, s39
    s_add_u32 m0, s33, 122880
    s_lshl_b32 s27, s36, s44
    buffer_load_dwordx4 v193, s[12:15], s27 offen sc1 lds
    buffer_load_dwordx4 v194, s[12:15], s27 offen offset:1024 sc1 lds
    s_add_u32 s36, s36, 4
    s_cmp_eq_u32 s36, 33
    s_cselect_b32 s36, 0, s36
    s_waitcnt vmcnt(6)
    s_barrier
    v_cmp_ne_u32 vcc, s78, v16
    s_cbranch_vccz L_hb_25
    v_and_b32 v8, 31, v1
    v_lshlrev_b32 v8, 4, v8
    s_mov_b32 s27, 0
L_poll_26:
    buffer_load_dword v9, v8, s[8:11], s43 offen sc1
    s_add_u32 s27, s27, 1
    s_waitcnt vmcnt(0)
    v_cmp_ne_u32 vcc, s78, v9
    s_cbranch_vccz L_pd_27
    s_sleep 1
    s_cmp_lt_u32 s27, 0x40000
    s_cbranch_scc1 L_poll_26
L_pd_27:
L_hb_25:
    s_lshr_b32 s35, s36, 2
    s_mul_i32 s35, s35, 14
    s_and_b32 s27, s36, 1
    s_add_u32 s35, s35, s27
    s_lshl_b32 s35, s35, 11
    s_add_u32 s33, s37, s38
    s_add_u32 m0, s33, 0
    s_nop 0
    buffer_load_dwordx4 v192, s[8:11], s35 offen offset:0 sc1 lds
    buffer_load_dwordx4 v192, s[8:11], s35 offen offset:1024 sc1 lds
    buffer_load_dwordx4 v197, s[8:11], s35 offen offset:2048 sc1 lds
    buffer_load_dwordx4 v197, s[8:11], s35 offen offset:3072 sc1 lds
    s_add_u32 s37, s37, 16384
    s_and_b32 s37, s37, 0xffff
    s_lshr_b32 s33, s37, 1
    s_add_u32 s33, s33, s39
    s_add_u32 m0, s33, 122880
    s_lshl_b32 s27, s36, s44
    buffer_load_dwordx4 v193, s[12:15], s27 offen sc1 lds
    buffer_load_dwordx4 v194, s[12:15], s27 offen offset:1024 sc1 lds
    s_add_u32 s36, s36, 4
    s_cmp_eq_u32 s36, 33
    s_cselect_b32 s36, 0, s36
    s_mov_b32 s41, 6
    s_add_u32 s34, s38, 0
    s_lshr_b32 s35, s36, 2
    s_mul_i32 s35, s35, 14
    s_and_b32 s27, s36, 1
    s_add_u32 s35, s35, s27
    s_lshl_b32 s35, s35, 11
    s_add_u32 m0, s37, s34
L_ps_28:
    s_waitcnt vmcnt(12)
    s_barrier
    buffer_load_dwordx4 v192, s[8:11], s35 offen offset:0 sc1 lds
    s_lshl_b32 s42, s36, s44
    s_add_u32 s37, s37, 16384
    s_and_b32 s37, s37, 0xffff
    s_lshr_b32 s33, s37, 1
    s_add_u32 s33, s33, s39
    buffer_load_dwordx4 v192, s[8:11], s35 offen offset:1024 sc1 lds
    s_add_u32 s36, s36, 4
    s_cmp_eq_u32 s36, 33
    buffer_load_dwordx4 v197, s[8:11], s35 offen offset:2048 sc1 lds
    s_cselect_b32 s36, 0, s36
    buffer_load_dwordx4 v197, s[8:11], s35 offen offset:3072 sc1 lds
    s_add_u32 m0, s33, 122880
    s_nop 0
    buffer_load_dwordx4 v193, s[12:15], s42 offen sc1 lds
    s_lshr_b32 s35, s36, 2
    s_mul_i32 s35, s35, 14
    s_and_b32 s27, s36, 1
    s_add_u32 s35, s35, s27
    s_lshl_b32 s35, s35, 11
    s_add_u32 s41, s41, 1
    buffer_load_dwordx4 v194, s[12:15], s42 offen offset:1024 sc1 lds
    s_add_u32 m0, s37, s34
    s_cmp_lt_u32 s41, 13
    s_cbranch_scc1 L_ps_28
    s_waitcnt vmcnt(12)
    s_barrier
    s_mov_b32 s12, s84
    s_mov_b32 s13, s85
    s_mov_b32 s14, 0x700000
    s_mov_b32 s15, 0x20000
    s_lshl_b32 s42, s51, 6
    s_add_u32 s43, s42, 128
    s_add_u32 s44, s42, 256
    s_lshl_b32 s45, s50, 6
    v_lshrrev_b32 v4, 3, v1
    v_and_b32 v5, 0x70, v233
    v_xor_b32 v6, 32, v5
    s_mov_b32 s28, 7168
    v_mul_lo_u32 v4, v4, s28
    v_add_u32 v5, v4, v5
    v_add_u32 v6, v4, v6
    s_mul_i32 s29, s26, 114688
    s_add_u32 s27, s29, s42
    v_add_u32 v14, s27, v5
    s_add_u32 s27, s29, s42
    s_add_u32 s27, s27, 57344
    v_add_u32 v15, s27, v6
    s_add_u32 s27, s29, s43
    v_add_u32 v16, s27, v5
    s_add_u32 s27, s29, s43
    s_add_u32 s27, s27, 57344
    v_add_u32 v17, s27, v6
    s_add_u32 s27, s29, s44
    v_add_u32 v18, s27, v5
    s_add_u32 s27, s29, s44
    s_add_u32 s27, s27, 57344
    v_add_u32 v19, s27, v6
    v_lshrrev_b32 v4, 2, v1
    v_and_b32 v5, 3, v1
    v_lshlrev_b32 v5, 4, v5
    v_bfe_u32 v6, v1, 4, 1
    v_lshlrev_b32 v6, 5, v6
    v_xor_b32 v5, v5, v6
    v_mul_lo_u32 v4, v4, s28
    v_add_u32 v4, v4, v5
    s_add_u32 s27, s29, s45
    v_add_u32 v20, s27, v4
    s_mov_b32 s61, 458752
    s_mul_i32 s36, s21, s61
    s_mov_b32 s47, s36
    s_lshl_b32 s63, s61, 4
    s_mov_b32 s37, 0
    s_waitcnt vmcnt(6)
    s_barrier
    s_add_u32 s33, s37, s39
    s_add_u32 m0, s33, 65536
    s_nop 0
    buffer_load_dwordx4 v14, s[12:15], s36 offen sc1 lds
    s_add_u32 m0, s33, 66560
    s_nop 0
    buffer_load_dwordx4 v15, s[12:15], s36 offen sc1 lds
    s_add_u32 m0, s33, 73728
    s_nop 0
    buffer_load_dwordx4 v16, s[12:15], s36 offen sc1 lds
    s_add_u32 m0, s33, 74752
    s_nop 0
    buffer_load_dwordx4 v17, s[12:15], s36 offen sc1 lds
    s_add_u32 m0, s33, 81920
    s_nop 0
    buffer_load_dwordx4 v18, s[12:15], s36 offen sc1 lds
    s_add_u32 m0, s33, 82944
    s_nop 0
    buffer_load_dwordx4 v19, s[12:15], s36 offen sc1 lds
    s_add_u32 s33, s37, s40
    s_add_u32 m0, s33, 90112
    s_nop 0
    buffer_load_dwordx4 v20, s[12:15], s36 offen sc1 lds
    s_mov_b32 s36, 0
    s_cmp_eq_u32 s36, s47
    s_cselect_b32 s27, s61, 0
    s_add_u32 s36, s36, s27
    s_add_u32 s37, s37, 28672
    s_cmp_eq_u32 s37, 86016
    s_cselect_b32 s37, 0, s37
    s_waitcnt vmcnt(7)
    s_barrier
    s_add_u32 s33, s37, s39
    s_add_u32 m0, s33, 65536
    s_nop 0
    buffer_load_dwordx4 v14, s[12:15], s36 offen sc1 lds
    s_add_u32 m0, s33, 66560
    s_nop 0
    buffer_load_dwordx4 v15, s[12:15], s36 offen sc1 lds
    s_add_u32 m0, s33, 73728
    s_nop 0
    buffer_load_dwordx4 v16, s[12:15], s36 offen sc1 lds
    s_add_u32 m0, s33, 74752
    s_nop 0
    buffer_load_dwordx4 v17, s[12:15], s36 offen sc1 lds
    s_add_u32 m0, s33, 81920
    s_nop 0
    buffer_load_dwordx4 v18, s[12:15], s36 offen sc1 lds
    s_add_u32 m0, s33, 82944
    s_nop 0
    buffer_load_dwordx4 v19, s[12:15], s36 offen sc1 lds
    s_add_u32 s33, s37, s40
    s_add_u32 m0, s33, 90112
    s_nop 0
    buffer_load_dwordx4 v20, s[12:15], s36 offen sc1 lds
    s_add_u32 s36, s36, s61
    s_cmp_eq_u32 s36, s63
    s_cselect_b32 s36, 0, s36
    s_cmp_eq_u32 s36, s47
    s_cselect_b32 s27, s61, 0
    s_add_u32 s36, s36, s27
    s_add_u32 s37, s37, 28672
    s_cmp_eq_u32 s37, 86016
    s_cselect_b32 s37, 0, s37
    s_barrier
    s_cmp_lg_u32 s22, 4
    s_cbranch_scc1 L_dnf_29
    s_lshr_b32 s29, s21, 1
    s_and_b32 s25, s21, 1
    s_lshl_b32 s25, s25, 4
    s_add_u32 s25, s25, s20
    s_lshl_b32 s27, s29, 9
    s_lshl_b32 s28, s25, 4
    s_add_u32 s27, s27, s28
    s_add_u32 s27, s27, 0x1a80000
    v_mov_b32 v4, 0
    v_mov_b32 v5, s78
    s_waitcnt vmcnt(63)
    s_mov_b64 exec, 1
    buffer_store_dword v5, v4, s[8:11], s27 offen sc1
    s_mov_b64 exec, -1
L_dnf_29:
    s_branch L_wo_done
L_wo_cons:
    s_setprio 1
    s_lshl_b32 s27, s88, 13
    s_add_u32 s27, s27, 0
    v_add_u32 v20, s27, v2
    v_lshrrev_b32 v3, 4, v1
    v_bfe_u32 v4, v1, 2, 2
    v_lshlrev_b32 v8, 2, v3
    v_add_u32 v8, v8, v4
    v_lshlrev_b32 v8, 7, v8
    v_and_b32 v5, 3, v1
    v_lshlrev_b32 v5, 3, v5
    v_and_b32 v6, 1, v3
    v_lshrrev_b32 v7, 5, v1
    v_xor_b32 v6, v6, v7
    v_lshlrev_b32 v6, 5, v6
    v_xor_b32 v5, v5, v6
    v_bfe_u32 v6, v1, 3, 1
    v_lshlrev_b32 v6, 6, v6
    v_xor_b32 v5, v5, v6
    s_lshl_b32 s27, s89, 6
    v_xor_b32 v5, s27, v5
    v_add_u32 v8, v8, v5
    v_add_u32 v21, 122880, v8
    v_xor_b32 v22, 32, v21
    v_lshlrev_b32 v32, 16, v240
    v_and_b32 v33, 0xffff0000, v240
    v_lshlrev_b32 v34, 16, v241
    v_and_b32 v35, 0xffff0000, v241
    v_lshlrev_b32 v36, 16, v242
    v_and_b32 v37, 0xffff0000, v242
    v_lshlrev_b32 v38, 16, v243
    v_and_b32 v39, 0xffff0000, v243
    v_lshlrev_b32 v40, 16, v244
    v_and_b32 v41, 0xffff0000, v244
    v_lshlrev_b32 v42, 16, v245
    v_and_b32 v43, 0xffff0000, v245
    v_lshlrev_b32 v44, 16, v246
    v_and_b32 v45, 0xffff0000, v246
    v_lshlrev_b32 v46, 16, v247
    v_and_b32 v47, 0xffff0000, v247
    v_lshlrev_b32 v48, 16, v248
    v_and_b32 v49, 0xffff0000, v248
    v_lshlrev_b32 v50, 16, v249
    v_and_b32 v51, 0xffff0000, v249
    v_lshlrev_b32 v52, 16, v250
    v_and_b32 v53, 0xffff0000, v250
    v_lshlrev_b32 v54, 16, v251
    v_and_b32 v55, 0xffff0000, v251
    v_lshlrev_b32 v56, 16, v252
    v_and_b32 v57, 0xffff0000, v252
    v_lshlrev_b32 v58, 16, v253
    v_and_b32 v59, 0xffff0000, v253
    v_lshlrev_b32 v60, 16, v254
    v_and_b32 v61, 0xffff0000, v254
    v_lshlrev_b32 v62, 16, v255
    v_and_b32 v63, 0xffff0000, v255
    s_mov_b32 s31, 8192
    s_mov_b32 s32, 0
    s_mov_b32 s30, 0
    v_add_u32 v23, s32, v20
    v_add_u32 v24, s31, v21
    v_add_u32 v25, s31, v22
    s_barrier
    ds_read_b128 v[96:99], v23 offset:0
    ds_read_b64_tr_b16 v[128:129], v24 offset:0
    ds_read_b64_tr_b16 v[130:131], v24 offset:2048
    ds_read_b128 v[100:103], v23 offset:1024
    ds_read_b128 v[104:107], v23 offset:4096
    ds_read_b128 v[108:111], v23 offset:5120
    ds_read_b64_tr_b16 v[132:133], v25 offset:0
    ds_read_b64_tr_b16 v[134:135], v25 offset:2048
    ds_read_b128 v[112:115], v23 offset:2048
    ds_read_b64_tr_b16 v[136:137], v24 offset:4096
    ds_read_b64_tr_b16 v[138:139], v24 offset:6144
    ds_read_b128 v[116:119], v23 offset:3072
    ds_read_b128 v[120:123], v23 offset:6144
    ds_read_b128 v[124:127], v23 offset:7168
    ds_read_b64_tr_b16 v[140:141], v25 offset:4096
L_cons_30:
    s_waitcnt lgkmcnt(7)
    v_mfma_f32_16x16x32_bf16 v[32:35], v[128:131], v[96:99], v[32:35]
    ds_read_b64_tr_b16 v[142:143], v25 offset:6144
    v_mfma_f32_16x16x32_bf16 v[40:43], v[128:131], v[100:103], v[40:43]
    s_add_u32 s32, s32, 16384
    v_mfma_f32_16x16x32_bf16 v[48:51], v[128:131], v[104:107], v[48:51]
    s_and_b32 s32, s32, 0xffff
    v_mfma_f32_16x16x32_bf16 v[56:59], v[128:131], v[108:111], v[56:59]
    s_add_u32 s31, s31, 8192
    s_cmp_eq_u32 s31, 32768
    v_mfma_f32_16x16x32_bf16 v[36:39], v[132:135], v[96:99], v[36:39]
    s_cselect_b32 s31, 0, s31
    s_add_u32 s30, s30, 1
    s_cmp_lt_u32 s30, 1
    v_add_u32 v23, s32, v20
    v_add_u32 v24, s31, v21
    v_add_u32 v25, s31, v22
    s_waitcnt lgkmcnt(0)
    s_barrier
    v_mfma_f32_16x16x32_bf16 v[44:47], v[132:135], v[100:103], v[44:47]
    ds_read_b128 v[96:99], v23 offset:0
    ds_read_b64_tr_b16 v[128:129], v24 offset:0
    ds_read_b64_tr_b16 v[130:131], v24 offset:2048
    ds_read_b128 v[100:103], v23 offset:1024
    v_mfma_f32_16x16x32_bf16 v[52:55], v[132:135], v[104:107], v[52:55]
    ds_read_b128 v[104:107], v23 offset:4096
    v_mfma_f32_16x16x32_bf16 v[60:63], v[132:135], v[108:111], v[60:63]
    ds_read_b128 v[108:111], v23 offset:5120
    ds_read_b64_tr_b16 v[132:133], v25 offset:0
    v_mfma_f32_16x16x32_bf16 v[32:35], v[136:139], v[112:115], v[32:35]
    ds_read_b64_tr_b16 v[134:135], v25 offset:2048
    v_mfma_f32_16x16x32_bf16 v[40:43], v[136:139], v[116:119], v[40:43]
    v_mfma_f32_16x16x32_bf16 v[48:51], v[136:139], v[120:123], v[48:51]
    v_mfma_f32_16x16x32_bf16 v[56:59], v[136:139], v[124:127], v[56:59]
    v_mfma_f32_16x16x32_bf16 v[36:39], v[140:143], v[112:115], v[36:39]
    ds_read_b128 v[112:115], v23 offset:2048
    ds_read_b64_tr_b16 v[136:137], v24 offset:4096
    v_mfma_f32_16x16x32_bf16 v[44:47], v[140:143], v[116:119], v[44:47]
    ds_read_b64_tr_b16 v[138:139], v24 offset:6144
    ds_read_b128 v[116:119], v23 offset:3072
    v_mfma_f32_16x16x32_bf16 v[52:55], v[140:143], v[120:123], v[52:55]
    ds_read_b128 v[120:123], v23 offset:6144
    v_mfma_f32_16x16x32_bf16 v[60:63], v[140:143], v[124:127], v[60:63]
    ds_read_b128 v[124:127], v23 offset:7168
    ds_read_b64_tr_b16 v[140:141], v25 offset:4096
    s_cbranch_scc1 L_cons_30
    s_add_u32 s29, s21, 16
    s_lshl_b32 s27, s3, 9
    s_lshl_b32 s28, s29, 4
    s_add_u32 s27, s27, s28
    s_add_u32 s27, s27, 0x1940000
    v_mov_b32 v4, 0
    v_mov_b32 v5, s78
    s_waitcnt vmcnt(0)
    s_mov_b64 exec, 1
    buffer_store_dword v5, v4, s[8:11], s27 offen sc1
    s_mov_b64 exec, -1
L_cons_31:
    s_waitcnt lgkmcnt(7)
    v_mfma_f32_16x16x32_bf16 v[32:35], v[128:131], v[96:99], v[32:35]
    ds_read_b64_tr_b16 v[142:143], v25 offset:6144
    v_mfma_f32_16x16x32_bf16 v[40:43], v[128:131], v[100:103], v[40:43]
    s_add_u32 s32, s32, 16384
    v_mfma_f32_16x16x32_bf16 v[48:51], v[128:131], v[104:107], v[48:51]
    s_and_b32 s32, s32, 0xffff
    v_mfma_f32_16x16x32_bf16 v[56:59], v[128:131], v[108:111], v[56:59]
    s_add_u32 s31, s31, 8192
    s_cmp_eq_u32 s31, 32768
    v_mfma_f32_16x16x32_bf16 v[36:39], v[132:135], v[96:99], v[36:39]
    s_cselect_b32 s31, 0, s31
    s_add_u32 s30, s30, 1
    s_cmp_lt_u32 s30, 16
    v_add_u32 v23, s32, v20
    v_add_u32 v24, s31, v21
    v_add_u32 v25, s31, v22
    s_waitcnt lgkmcnt(0)
    s_barrier
    v_mfma_f32_16x16x32_bf16 v[44:47], v[132:135], v[100:103], v[44:47]
    ds_read_b128 v[96:99], v23 offset:0
    ds_read_b64_tr_b16 v[128:129], v24 offset:0
    ds_read_b64_tr_b16 v[130:131], v24 offset:2048
    ds_read_b128 v[100:103], v23 offset:1024
    v_mfma_f32_16x16x32_bf16 v[52:55], v[132:135], v[104:107], v[52:55]
    ds_read_b128 v[104:107], v23 offset:4096
    v_mfma_f32_16x16x32_bf16 v[60:63], v[132:135], v[108:111], v[60:63]
    ds_read_b128 v[108:111], v23 offset:5120
    ds_read_b64_tr_b16 v[132:133], v25 offset:0
    v_mfma_f32_16x16x32_bf16 v[32:35], v[136:139], v[112:115], v[32:35]
    ds_read_b64_tr_b16 v[134:135], v25 offset:2048
    v_mfma_f32_16x16x32_bf16 v[40:43], v[136:139], v[116:119], v[40:43]
    v_mfma_f32_16x16x32_bf16 v[48:51], v[136:139], v[120:123], v[48:51]
    v_mfma_f32_16x16x32_bf16 v[56:59], v[136:139], v[124:127], v[56:59]
    v_mfma_f32_16x16x32_bf16 v[36:39], v[140:143], v[112:115], v[36:39]
    ds_read_b128 v[112:115], v23 offset:2048
    ds_read_b64_tr_b16 v[136:137], v24 offset:4096
    v_mfma_f32_16x16x32_bf16 v[44:47], v[140:143], v[116:119], v[44:47]
    ds_read_b64_tr_b16 v[138:139], v24 offset:6144
    ds_read_b128 v[116:119], v23 offset:3072
    v_mfma_f32_16x16x32_bf16 v[52:55], v[140:143], v[120:123], v[52:55]
    ds_read_b128 v[120:123], v23 offset:6144
    v_mfma_f32_16x16x32_bf16 v[60:63], v[140:143], v[124:127], v[60:63]
    ds_read_b128 v[124:127], v23 offset:7168
    ds_read_b64_tr_b16 v[140:141], v25 offset:4096
    s_cbranch_scc1 L_cons_31
    s_waitcnt lgkmcnt(0)
    s_nop 7
    v_cvt_pk_bf16_f32 v240, v32, v33
    v_cvt_pk_bf16_f32 v241, v34, v35
    v_cvt_pk_bf16_f32 v242, v36, v37
    v_cvt_pk_bf16_f32 v243, v38, v39
    v_cvt_pk_bf16_f32 v244, v40, v41
    v_cvt_pk_bf16_f32 v245, v42, v43
    v_cvt_pk_bf16_f32 v246, v44, v45
    v_cvt_pk_bf16_f32 v247, v46, v47
    v_cvt_pk_bf16_f32 v248, v48, v49
    v_cvt_pk_bf16_f32 v249, v50, v51
    v_cvt_pk_bf16_f32 v250, v52, v53
    v_cvt_pk_bf16_f32 v251, v54, v55
    v_cvt_pk_bf16_f32 v252, v56, v57
    v_cvt_pk_bf16_f32 v253, v58, v59
    v_cvt_pk_bf16_f32 v254, v60, v61
    v_cvt_pk_bf16_f32 v255, v62, v63
    s_lshl_b32 s27, s6, 5
    s_add_u32 s27, s27, s21
    s_mul_i32 s27, s27, 6144
    s_lshl_b32 s28, s89, 11
    s_add_u32 s27, s27, s28
    s_add_u32 s27, s27, 0x1000000
    s_add_u32 s29, s27, 98304
    buffer_store_dwordx4 v[240:243], v2, s[8:11], s27 offen offset:0 sc1
    buffer_store_dwordx4 v[244:247], v2, s[8:11], s27 offen offset:1024 sc1
    buffer_store_dwordx4 v[248:251], v2, s[8:11], s29 offen offset:0 sc1
    buffer_store_dwordx4 v[252:255], v2, s[8:11], s29 offen offset:1024 sc1
    s_lshl_b32 s27, s88, 13
    s_lshl_b32 s28, s89, 11
    s_add_u32 s27, s27, s28
    v_add_u32 v10, s27, v2
    ds_write_b128 v10, v[240:243] offset:0
    ds_write_b128 v10, v[244:247] offset:1024
    ds_write_b128 v10, v[248:251] offset:4096
    ds_write_b128 v10, v[252:255] offset:5120
    s_lshl_b32 s29, s6, 9
    s_lshl_b32 s28, s7, 4
    s_add_u32 s29, s29, s28
    s_add_u32 s29, s29, 0x1980000
    v_mov_b32 v3, 0x3f803f80
    v_mov_b32 v12, 0
    v_mov_b32 v13, 0
    v_mov_b32 v14, 0
    v_mov_b32 v15, 0
    v_mov_b32 v16, 0
    v_mov_b32 v17, 0
    v_mov_b32 v18, 0
    v_mov_b32 v19, 0
    v_dot2_f32_bf16 v12, v240, v3, v12
    v_dot2_f32_bf16 v13, v240, v240, v13
    v_dot2_f32_bf16 v14, v244, v3, v14
    v_dot2_f32_bf16 v15, v244, v244, v15
    v_dot2_f32_bf16 v16, v248, v3, v16
    v_dot2_f32_bf16 v17, v248, v248, v17
    v_dot2_f32_bf16 v18, v252, v3, v18
    v_dot2_f32_bf16 v19, v252, v252, v19
    v_dot2_f32_bf16 v12, v241, v3, v12
    v_dot2_f32_bf16 v13, v241, v241, v13
    v_dot2_f32_bf16 v14, v245, v3, v14
    v_dot2_f32_bf16 v15, v245, v245, v15
    v_dot2_f32_bf16 v16, v249, v3, v16
    v_dot2_f32_bf16 v17, v249, v249, v17
    v_dot2_f32_bf16 v18, v253, v3, v18
    v_dot2_f32_bf16 v19, v253, v253, v19
    v_dot2_f32_bf16 v12, v242, v3, v12
    v_dot2_f32_bf16 v13, v242, v242, v13
    v_dot2_f32_bf16 v14, v246, v3, v14
    v_dot2_f32_bf16 v15, v246, v246, v15
    v_dot2_f32_bf16 v16, v250, v3, v16
    v_dot2_f32_bf16 v17, v250, v250, v17
    v_dot2_f32_bf16 v18, v254, v3, v18
    v_dot2_f32_bf16 v19, v254, v254, v19
    v_dot2_f32_bf16 v12, v243, v3, v12
    v_dot2_f32_bf16 v13, v243, v243, v13
    v_dot2_f32_bf16 v14, v247, v3, v14
    v_dot2_f32_bf16 v15, v247, v247, v15
    v_dot2_f32_bf16 v16, v251, v3, v16
    v_dot2_f32_bf16 v17, v251, v251, v17
    v_dot2_f32_bf16 v18, v255, v3, v18
    v_dot2_f32_bf16 v19, v255, v255, v19
    s_lshl_b32 s27, s6, 14
    s_lshl_b32 s28, s21, 10
    s_add_u32 s27, s27, s28
    s_lshl_b32 s28, s89, 3
    s_add_u32 s27, s27, s28
    s_add_u32 s27, s27, 0x1680000
    v_permlane32_swap_b32 v12, v16
    v_permlane32_swap_b32 v13, v17
    v_permlane32_swap_b32 v14, v18
    v_permlane32_swap_b32 v15, v19
    v_add_f32 v12, v12, v16
    v_add_f32 v13, v13, v17
    v_add_f32 v14, v14, v18
    v_add_f32 v15, v15, v19
    s_nop 1
    v_permlane16_swap_b32 v12, v14
    v_permlane16_swap_b32 v13, v15
    v_add_f32 v16, v12, v14
    v_add_f32 v17, v13, v15
    buffer_store_dwordx2 v[16:17], v2, s[8:11], s27 offen sc1
    v_mov_b32 v4, 0
    v_mov_b32 v5, s78
    s_waitcnt vmcnt(0)
    s_mov_b64 exec, 1
    buffer_store_dword v5, v4, s[8:11], s29 offen sc1
    s_mov_b64 exec, -1
    s_waitcnt lgkmcnt(0)
    s_setprio 0
L_wo_done:
    s_cmp_ge_u32 s22, 4
    s_cbranch_scc0 L_f1_cons
    s_add_u32 s52, s4, 0x1000000
    s_addc_u32 s53, s5, 0
    s_mov_b32 s54, 0x600000
    s_mov_b32 s60, 6144
    s_mul_i32 s27, s24, 98304
    v_add_u32 v10, s27, v2
    v_add_u32 v11, s27, v2
    v_add_u32 v12, s27, v2
    v_add_u32 v13, s27, v2
    s_lshl_b32 s62, s60, 4
    s_cmp_lt_u32 s26, 4
    s_cselect_b32 s32, 1, 0
    s_cmp_eq_u32 s23, 0
    s_cselect_b32 s32, s32, 0
    s_mul_i32 s34, s32, 63
    s_and_b32 s46, s20, 1
    s_lshl_b32 s34, s34, s46
    s_mov_b32 s41, 0
    s_mul_i32 s43, s21, s60
    s_cmp_eq_u32 s43, 0
    s_cselect_b32 s35, s60, 0
    s_mov_b32 s45, 16384
    s_lshr_b32 s29, s24, 1
    s_lshl_b32 s25, s29, 9
    s_add_u32 s25, s25, 0x1980000
    s_waitcnt vmcnt(7)
    s_barrier
    v_and_b32 v8, 31, v1
    v_lshlrev_b32 v8, 4, v8
    buffer_load_dword v9, v8, s[8:11], s25 offen sc1
    s_add_u32 s33, s37, s39
    s_add_u32 m0, s33, 65536
    s_nop 0
    buffer_load_dwordx4 v14, s[12:15], s36 offen sc1 lds
    s_add_u32 m0, s33, 66560
    s_nop 0
    buffer_load_dwordx4 v15, s[12:15], s36 offen sc1 lds
    s_add_u32 m0, s33, 73728
    s_nop 0
    buffer_load_dwordx4 v16, s[12:15], s36 offen sc1 lds
    s_add_u32 m0, s33, 74752
    s_nop 0
    buffer_load_dwordx4 v17, s[12:15], s36 offen sc1 lds
    s_add_u32 m0, s33, 81920
    s_nop 0
    buffer_load_dwordx4 v18, s[12:15], s36 offen sc1 lds
    s_add_u32 m0, s33, 82944
    s_nop 0
    buffer_load_dwordx4 v19, s[12:15], s36 offen sc1 lds
    s_add_u32 s33, s37, s40
    s_add_u32 m0, s33, 90112
    s_nop 0
    buffer_load_dwordx4 v20, s[12:15], s36 offen sc1 lds
    s_add_u32 s36, s36, s61
    s_cmp_eq_u32 s36, s63
    s_cselect_b32 s36, 0, s36
    s_cmp_eq_u32 s36, s47
    s_cselect_b32 s27, s61, 0
    s_add_u32 s36, s36, s27
    s_add_u32 s37, s37, 28672
    s_cmp_eq_u32 s37, 86016
    s_cselect_b32 s37, 0, s37
    s_waitcnt vmcnt(7)
    v_cmp_ne_u32 vcc, s78, v9
    s_cbranch_vccz L_fp_rdy
    v_and_b32 v8, 31, v1
    v_lshlrev_b32 v8, 4, v8
    s_mov_b32 s27, 0
L_poll_32:
    buffer_load_dword v9, v8, s[8:11], s25 offen sc1
    s_add_u32 s27, s27, 1
    s_waitcnt vmcnt(0)
    v_cmp_ne_u32 vcc, s78, v9
    s_cbranch_vccz L_pd_33
    s_sleep 1
    s_cmp_lt_u32 s27, 0x40000
    s_cbranch_scc1 L_poll_32
L_pd_33:
L_fp_rdy:
    s_add_u32 m0, s45, s38
    s_add_u32 s45, s45, 16384
    buffer_load_dwordx4 v10, s[52:55], s35 offen offset:0 sc1 lds
    buffer_load_dwordx4 v11, s[52:55], s35 offen offset:1024 sc1 lds
    buffer_load_dwordx4 v12, s[52:55], s35 offen offset:2048 sc1 lds
    buffer_load_dwordx4 v13, s[52:55], s35 offen offset:3072 sc1 lds
    s_and_b32 s45, s45, 0xffff
    s_add_u32 s35, s35, s60
    s_cmp_eq_u32 s35, s62
    s_cselect_b32 s35, 0, s35
    s_cmp_eq_u32 s35, s43
    s_cselect_b32 s27, s60, 0
    s_add_u32 s35, s35, s27
    s_add_u32 m0, s45, s38
    s_add_u32 s45, s45, 16384
    buffer_load_dwordx4 v10, s[52:55], s35 offen offset:0 sc1 lds
    buffer_load_dwordx4 v11, s[52:55], s35 offen offset:1024 sc1 lds
    buffer_load_dwordx4 v12, s[52:55], s35 offen offset:2048 sc1 lds
    buffer_load_dwordx4 v13, s[52:55], s35 offen offset:3072 sc1 lds
    s_and_b32 s45, s45, 0xffff
    s_add_u32 s35, s35, s60
    s_cmp_eq_u32 s35, s62
    s_cselect_b32 s35, 0, s35
    s_cmp_eq_u32 s35, s43
    s_cselect_b32 s27, s60, 0
    s_add_u32 s35, s35, s27
    s_add_u32 m0, s45, s38
    s_add_u32 s45, s45, 16384
    buffer_load_dwordx4 v10, s[52:55], s35 offen offset:0 sc1 lds
    buffer_load_dwordx4 v11, s[52:55], s35 offen offset:1024 sc1 lds
    buffer_load_dwordx4 v12, s[52:55], s35 offen offset:2048 sc1 lds
    buffer_load_dwordx4 v13, s[52:55], s35 offen offset:3072 sc1 lds
    s_and_b32 s45, s45, 0xffff
    s_add_u32 s35, s35, s60
    s_cmp_eq_u32 s35, s62
    s_cselect_b32 s35, 0, s35
    s_cmp_eq_u32 s35, s43
    s_cselect_b32 s27, s60, 0
    s_add_u32 s35, s35, s27
    s_mov_b32 s41, 1
    s_waitcnt vmcnt(8)
    s_branch L_fp_bar
L_fp_loop:
    s_waitcnt vmcnt(15)
L_fp_bar:
    s_barrier
L_fp_go:
    s_add_u32 s33, s37, s39
    s_add_u32 m0, s33, 65536
    s_nop 0
    buffer_load_dwordx4 v14, s[12:15], s36 offen sc1 lds
    s_add_u32 m0, s33, 66560
    s_nop 0
    buffer_load_dwordx4 v15, s[12:15], s36 offen sc1 lds
    s_add_u32 m0, s33, 73728
    s_nop 0
    buffer_load_dwordx4 v16, s[12:15], s36 offen sc1 lds
    s_add_u32 m0, s33, 74752
    s_nop 0
    buffer_load_dwordx4 v17, s[12:15], s36 offen sc1 lds
    s_add_u32 m0, s33, 81920
    s_nop 0
    buffer_load_dwordx4 v18, s[12:15], s36 offen sc1 lds
    s_add_u32 m0, s33, 82944
    s_nop 0
    buffer_load_dwordx4 v19, s[12:15], s36 offen sc1 lds
    s_add_u32 s33, s37, s40
    s_add_u32 m0, s33, 90112
    s_nop 0
    buffer_load_dwordx4 v20, s[12:15], s36 offen sc1 lds
    s_add_u32 s36, s36, s61
    s_cmp_eq_u32 s36, s63
    s_cselect_b32 s36, 0, s36
    s_cmp_eq_u32 s36, s47
    s_cselect_b32 s27, s61, 0
    s_add_u32 s36, s36, s27
    s_add_u32 s37, s37, 28672
    s_cmp_eq_u32 s37, 86016
    s_cselect_b32 s37, 0, s37
    s_add_u32 m0, s45, s38
    s_add_u32 s45, s45, 16384
    buffer_load_dwordx4 v10, s[52:55], s35 offen offset:0 sc1 lds
    buffer_load_dwordx4 v11, s[52:55], s35 offen offset:1024 sc1 lds
    buffer_load_dwordx4 v12, s[52:55], s35 offen offset:2048 sc1 lds
    buffer_load_dwordx4 v13, s[52:55], s35 offen offset:3072 sc1 lds
    s_and_b32 s45, s45, 0xffff
    s_add_u32 s35, s35, s60
    s_cmp_eq_u32 s35, s62
    s_cselect_b32 s35, 0, s35
    s_cmp_eq_u32 s35, s43
    s_cselect_b32 s27, s60, 0
    s_add_u32 s35, s35, s27
L_fp_ret:
    s_add_u32 s41, s41, 1
    s_cmp_lt_u32 s41, 13
    s_cbranch_scc1 L_fp_loop
    s_waitcnt vmcnt(15)
    s_barrier
    v_and_b32 v7, 31, v1
    v_lshlrev_b32 v7, 4, v7
    s_lshr_b32 s29, s21, 1
    s_lshl_b32 s25, s29, 9
    s_add_u32 s25, s25, 0x1a80000
    buffer_load_dword v98, v7, s[8:11], s25 offen sc1
    s_add_u32 s33, s37, s39
    s_add_u32 m0, s33, 65536
    s_nop 0
    buffer_load_dwordx4 v14, s[12:15], s36 offen sc1 lds
    s_add_u32 m0, s33, 66560
    s_nop 0
    buffer_load_dwordx4 v15, s[12:15], s36 offen sc1 lds
    s_add_u32 m0, s33, 73728
    s_nop 0
    buffer_load_dwordx4 v16, s[12:15], s36 offen sc1 lds
    s_add_u32 m0, s33, 74752
    s_nop 0
    buffer_load_dwordx4 v17, s[12:15], s36 offen sc1 lds
    s_add_u32 m0, s33, 81920
    s_nop 0
    buffer_load_dwordx4 v18, s[12:15], s36 offen sc1 lds
    s_add_u32 m0, s33, 82944
    s_nop 0
    buffer_load_dwordx4 v19, s[12:15], s36 offen sc1 lds
    s_add_u32 s33, s37, s40
    s_add_u32 m0, s33, 90112
    s_nop 0
    buffer_load_dwordx4 v20, s[12:15], s36 offen sc1 lds
    s_add_u32 s36, s36, s61
    s_cmp_eq_u32 s36, s63
    s_cselect_b32 s36, 0, s36
    s_cmp_eq_u32 s36, s47
    s_cselect_b32 s27, s61, 0
    s_add_u32 s36, s36, s27
    s_add_u32 s37, s37, 28672
    s_cmp_eq_u32 s37, 86016
    s_cselect_b32 s37, 0, s37
    s_waitcnt vmcnt(12)
    s_barrier
    s_waitcnt vmcnt(7)
    v_cmp_ne_u32 vcc, s78, v98
    s_cbranch_vccz L_dn_34
    v_and_b32 v8, 31, v1
    v_lshlrev_b32 v8, 4, v8
    s_mov_b32 s27, 0
L_poll_35:
    buffer_load_dword v9, v8, s[8:11], s25 offen sc1
    s_add_u32 s27, s27, 1
    s_waitcnt vmcnt(0)
    v_cmp_ne_u32 vcc, s78, v9
    s_cbranch_vccz L_pd_36
    s_sleep 1
    s_cmp_lt_u32 s27, 0x40000
    s_cbranch_scc1 L_poll_35
L_pd_36:
L_dn_34:
    v_lshrrev_b32 v6, 5, v1
    v_lshlrev_b32 v6, 10, v6
    v_and_b32 v7, 31, v1
    v_lshlrev_b32 v7, 4, v7
    v_add_u32 v7, v7, v6
    s_lshr_b32 s27, s24, 1
    s_lshl_b32 s27, s27, 14
    s_and_b32 s28, s24, 1
    s_lshl_b32 s28, s28, 9
    s_add_u32 s27, s27, s28
    s_add_u32 s27, s27, 0x1680000
    buffer_load_dwordx4 v[32:35], v7, s[8:11], s27 offen offset:0 sc1
    buffer_load_dwordx4 v[36:39], v7, s[8:11], s27 offen offset:2048 sc1
    s_add_u32 s27, s27, 4096
    buffer_load_dwordx4 v[40:43], v7, s[8:11], s27 offen offset:0 sc1
    buffer_load_dwordx4 v[44:47], v7, s[8:11], s27 offen offset:2048 sc1
    s_add_u32 s27, s27, 4096
    buffer_load_dwordx4 v[48:51], v7, s[8:11], s27 offen offset:0 sc1
    buffer_load_dwordx4 v[52:55], v7, s[8:11], s27 offen offset:2048 sc1
    s_add_u32 s27, s27, 4096
    buffer_load_dwordx4 v[56:59], v7, s[8:11], s27 offen offset:0 sc1
    buffer_load_dwordx4 v[60:63], v7, s[8:11], s27 offen offset:2048 sc1
    s_cmp_eq_u32 s32, 0
    s_cbranch_scc1 L_hc_37
    v_lshlrev_b32 v7, 3, v1
    s_lshl_b32 s27, s21, 15
    s_lshl_b32 s28, s26, 13
    s_add_u32 s27, s27, s28
    s_add_u32 s27, s27, 0x1880000
    s_add_u32 s28, s27, 4096
    buffer_load_dwordx2 v[100:101], v7, s[8:11], s27 offen offset:0 sc1
    buffer_load_dwordx2 v[102:103], v7, s[8:11], s27 offen offset:512 sc1
    buffer_load_dwordx2 v[104:105], v7, s[8:11], s27 offen offset:1024 sc1
    buffer_load_dwordx2 v[106:107], v7, s[8:11], s27 offen offset:1536 sc1
    buffer_load_dwordx2 v[108:109], v7, s[8:11], s27 offen offset:2048 sc1
    buffer_load_dwordx2 v[110:111], v7, s[8:11], s27 offen offset:2560 sc1
    buffer_load_dwordx2 v[112:113], v7, s[8:11], s27 offen offset:3072 sc1
    buffer_load_dwordx2 v[114:115], v7, s[8:11], s27 offen offset:3584 sc1
    buffer_load_dwordx2 v[116:117], v7, s[8:11], s28 offen offset:0 sc1
    buffer_load_dwordx2 v[118:119], v7, s[8:11], s28 offen offset:512 sc1
    buffer_load_dwordx2 v[120:121], v7, s[8:11], s28 offen offset:1024 sc1
    buffer_load_dwordx2 v[122:123], v7, s[8:11], s28 offen offset:1536 sc1
    buffer_load_dwordx2 v[124:125], v7, s[8:11], s28 offen offset:2048 sc1
    buffer_load_dwordx2 v[126:127], v7, s[8:11], s28 offen offset:2560 sc1
    buffer_load_dwordx2 v[128:129], v7, s[8:11], s28 offen offset:3072 sc1
    buffer_load_dwordx2 v[130:131], v7, s[8:11], s28 offen offset:3584 sc1
L_hc_37:
    s_xor_b32 s49, s21, 1
    v_lshrrev_b32 v4, 3, v1
    v_lshlrev_b32 v4, 11, v4
    v_and_b32 v5, 0x70, v233
    v_add_u32 v4, v4, v5
    v_xor_b32 v5, 32, v4
    s_mov_b32 s29, s26
    s_mov_b32 s15, 0x20000
    s_and_b32 s27, s49, 7
    s_cmp_eq_u32 s27, 3
    s_cbranch_scc1 L_wl_40
    s_mov_b32 s12, s86
    s_mov_b32 s13, s87
    s_mov_b32 s14, 0x700000
    s_mov_b32 s44, 17
    s_lshl_b32 s27, s29, 15
    s_lshl_b32 s28, s49, 7
    s_add_u32 s27, s27, s28
    s_add_u32 s28, s27, 15360
    v_add_u32 v193, s27, v4
    v_add_u32 v194, s28, v5
    s_branch L_wd_41
L_wl_40:
    s_add_u32 s12, s4, 0x1e00000
    s_addc_u32 s13, s5, 0
    s_mov_b32 s14, 0x100000
    s_mov_b32 s44, 13
    s_lshr_b32 s27, s49, 3
    s_mul_i32 s27, s27, 458752
    s_lshl_b32 s28, s29, 11
    s_add_u32 s27, s27, s28
    v_add_u32 v193, s27, v2
    v_mov_b32 v194, v193
L_wd_41:
    s_mov_b32 s67, 0x20000
    s_and_b32 s27, s21, 7
    s_cmp_eq_u32 s27, 3
    s_cbranch_scc1 L_wl_42
    s_mov_b32 s64, s86
    s_mov_b32 s65, s87
    s_mov_b32 s66, 0x700000
    s_mov_b32 s48, 17
    s_lshl_b32 s27, s29, 15
    s_lshl_b32 s28, s21, 7
    s_add_u32 s27, s27, s28
    s_add_u32 s28, s27, 15360
    v_add_u32 v195, s27, v4
    v_add_u32 v196, s28, v5
    s_branch L_wd_43
L_wl_42:
    s_add_u32 s64, s4, 0x1e00000
    s_addc_u32 s65, s5, 0
    s_mov_b32 s66, 0x100000
    s_mov_b32 s48, 13
    s_lshr_b32 s27, s21, 3
    s_mul_i32 s27, s27, 458752
    s_lshl_b32 s28, s29, 11
    s_add_u32 s27, s27, s28
    v_add_u32 v195, s27, v2
    v_mov_b32 v196, v195
L_wd_43:
    s_lshr_b32 s28, s51, 1
    s_add_u32 s28, s28, 0
    s_add_u32 m0, s39, 0
    s_lshl_b32 s27, s28, s44
    buffer_load_dwordx4 v193, s[12:15], s27 offen sc1 lds
    buffer_load_dwordx4 v194, s[12:15], s27 offen offset:1024 sc1 lds
    s_add_u32 m0, s39, 8192
    s_lshl_b32 s27, s28, s48
    buffer_load_dwordx4 v195, s[64:67], s27 offen sc1 lds
    buffer_load_dwordx4 v196, s[64:67], s27 offen offset:1024 sc1 lds
    s_lshr_b32 s28, s51, 1
    s_add_u32 s28, s28, 1
    s_add_u32 m0, s39, 16384
    s_lshl_b32 s27, s28, s44
    buffer_load_dwordx4 v193, s[12:15], s27 offen sc1 lds
    buffer_load_dwordx4 v194, s[12:15], s27 offen offset:1024 sc1 lds
    s_add_u32 m0, s39, 24576
    s_lshl_b32 s27, s28, s48
    buffer_load_dwordx4 v195, s[64:67], s27 offen sc1 lds
    buffer_load_dwordx4 v196, s[64:67], s27 offen offset:1024 sc1 lds
    s_waitcnt vmcnt(16)
    s_barrier
    s_lshr_b32 s28, s51, 1
    s_add_u32 s28, s28, 2
    s_add_u32 m0, s39, 32768
    s_lshl_b32 s27, s28, s44
    buffer_load_dwordx4 v193, s[12:15], s27 offen sc1 lds
    buffer_load_dwordx4 v194, s[12:15], s27 offen offset:1024 sc1 lds
    s_add_u32 m0, s39, 40960
    s_lshl_b32 s27, s28, s48
    buffer_load_dwordx4 v195, s[64:67], s27 offen sc1 lds
    buffer_load_dwordx4 v196, s[64:67], s27 offen offset:1024 sc1 lds
    s_waitcnt vmcnt(12)
    v_pk_add_f32 v[32:33], v[32:33], v[48:49]
    v_pk_add_f32 v[34:35], v[34:35], v[50:51]
    v_pk_add_f32 v[36:37], v[36:37], v[52:53]
    v_pk_add_f32 v[38:39], v[38:39], v[54:55]
    v_pk_add_f32 v[40:41], v[40:41], v[56:57]
    v_pk_add_f32 v[42:43], v[42:43], v[58:59]
    v_pk_add_f32 v[44:45], v[44:45], v[60:61]
    v_pk_add_f32 v[46:47], v[46:47], v[62:63]
    v_pk_add_f32 v[32:33], v[32:33], v[40:41]
    v_pk_add_f32 v[34:35], v[34:35], v[42:43]
    v_pk_add_f32 v[36:37], v[36:37], v[44:45]
    v_pk_add_f32 v[38:39], v[38:39], v[46:47]
    v_pk_add_f32 v[32:33], v[32:33], v[36:37]
    v_pk_add_f32 v[34:35], v[34:35], v[38:39]
    v_pk_add_f32 v[32:33], v[32:33], v[34:35]
    v_mov_b32 v34, v32
    v_mov_b32 v35, v33
    s_nop 1
    v_permlane32_swap_b32 v32, v34
    v_permlane32_swap_b32 v33, v35
    v_add_f32 v32, v32, v34
    v_add_f32 v33, v33, v35
    v_mul_f32 v36, 0xba800000, v32
    v_mul_f32 v38, 0x3a800000, v33
    v_fma_f32 v38, -v36, v36, v38
    v_max_f32 v38, 0, v38
    v_add_f32 v38, 0x3727c5ac, v38
    v_rsq_f32 v37, v38
    s_lshl_b32 s27, s26, 7
    s_add_u32 s27, s27, 159744
    v_and_b32 v7, 31, v1
    v_lshlrev_b32 v7, 2, v7
    v_add_u32 v7, s27, v7
    ds_write_b32 v7, v36
    ds_write_b32 v7, v37 offset:512
    s_cmp_eq_u32 s32, 0
    s_cbranch_scc1 L_he_39
    s_mov_b32 s29, 0
L_hr_44:
    v_bitop3_b32 v140, v101, v103, s78 bitop3:0x7e
    v_bitop3_b32 v141, v105, v107, s78 bitop3:0x7e
    v_bitop3_b32 v142, v109, v111, s78 bitop3:0x7e
    v_bitop3_b32 v143, v113, v115, s78 bitop3:0x7e
    v_bitop3_b32 v144, v117, v119, s78 bitop3:0x7e
    v_bitop3_b32 v145, v121, v123, s78 bitop3:0x7e
    v_bitop3_b32 v146, v125, v127, s78 bitop3:0x7e
    v_bitop3_b32 v147, v129, v131, s78 bitop3:0x7e
    v_or3_b32 v140, v140, v141, v142
    v_or3_b32 v143, v143, v144, v145
    v_or3_b32 v140, v140, v146, v147
    v_or_b32 v140, v140, v143
    v_cmp_ne_u32 vcc, 0, v140
    s_cbranch_vccz L_ho_45
    v_lshlrev_b32 v7, 3, v1
    s_lshl_b32 s27, s21, 15
    s_lshl_b32 s28, s26, 13
    s_add_u32 s27, s27, s28
    s_add_u32 s27, s27, 0x1880000
    s_add_u32 s28, s27, 4096
    buffer_load_dwordx2 v[100:101], v7, s[8:11], s27 offen offset:0 sc1
    buffer_load_dwordx2 v[102:103], v7, s[8:11], s27 offen offset:512 sc1
    buffer_load_dwordx2 v[104:105], v7, s[8:11], s27 offen offset:1024 sc1
    buffer_load_dwordx2 v[106:107], v7, s[8:11], s27 offen offset:1536 sc1
    buffer_load_dwordx2 v[108:109], v7, s[8:11], s27 offen offset:2048 sc1
    buffer_load_dwordx2 v[110:111], v7, s[8:11], s27 offen offset:2560 sc1
    buffer_load_dwordx2 v[112:113], v7, s[8:11], s27 offen offset:3072 sc1
    buffer_load_dwordx2 v[114:115], v7, s[8:11], s27 offen offset:3584 sc1
    buffer_load_dwordx2 v[116:117], v7, s[8:11], s28 offen offset:0 sc1
    buffer_load_dwordx2 v[118:119], v7, s[8:11], s28 offen offset:512 sc1
    buffer_load_dwordx2 v[120:121], v7, s[8:11], s28 offen offset:1024 sc1
    buffer_load_dwordx2 v[122:123], v7, s[8:11], s28 offen offset:1536 sc1
    buffer_load_dwordx2 v[124:125], v7, s[8:11], s28 offen offset:2048 sc1
    buffer_load_dwordx2 v[126:127], v7, s[8:11], s28 offen offset:2560 sc1
    buffer_load_dwordx2 v[128:129], v7, s[8:11], s28 offen offset:3072 sc1
    buffer_load_dwordx2 v[130:131], v7, s[8:11], s28 offen offset:3584 sc1
    s_add_u32 s29, s29, 1
    s_waitcnt vmcnt(0)
    s_cmp_lt_u32 s29, 0x40000
    s_cbranch_scc1 L_hr_44
L_ho_45:
    v_add_f32 v100, v100, v102
    v_add_f32 v100, v100, v104
    v_add_f32 v100, v100, v106
    v_add_f32 v100, v100, v108
    v_add_f32 v100, v100, v110
    v_add_f32 v100, v100, v112
    v_add_f32 v100, v100, v114
    v_add_f32 v100, v100, v116
    v_add_f32 v100, v100, v118
    v_add_f32 v100, v100, v120
    v_add_f32 v100, v100, v122
    v_add_f32 v100, v100, v124
    v_add_f32 v100, v100, v126
    v_add_f32 v100, v100, v128
    v_add_f32 v100, v100, v130
    s_cmp_lt_u32 s26, 3
    s_cbranch_scc1 L_hz_46
    s_nop 0
    v_add_f32_dpp v100, v100, v100 row_shl:4 row_mask:0xf bank_mask:0xf
L_hz_46:
    s_lshl_b32 s27, s26, 8
    s_add_u32 s27, s27, 160768
    v_and_b32 v7, 7, v1
    v_lshlrev_b32 v7, 5, v7
    v_lshrrev_b32 v6, 3, v1
    v_lshlrev_b32 v6, 2, v6
    v_add3_u32 v7, v7, v6, s27
    ds_write_b32 v7, v100
L_he_39:
    s_waitcnt lgkmcnt(0)
    s_barrier
    s_branch L_f1_done
L_f1_cons:
    s_setprio 1
    s_lshl_b32 s27, s88, 13
    v_add_u32 v56, s27, v2
    v_lshrrev_b32 v3, 4, v1
    v_bfe_u32 v4, v1, 2, 2
    v_lshlrev_b32 v8, 2, v3
    v_add_u32 v8, v8, v4
    v_lshlrev_b32 v8, 7, v8
    v_and_b32 v5, 3, v1
    v_lshlrev_b32 v5, 3, v5
    v_and_b32 v6, 1, v3
    v_lshrrev_b32 v7, 5, v1
    v_xor_b32 v6, v6, v7
    v_lshlrev_b32 v6, 5, v6
    v_xor_b32 v5, v5, v6
    v_bfe_u32 v6, v1, 3, 1
    v_lshlrev_b32 v6, 6, v6
    v_xor_b32 v5, v5, v6
    s_lshl_b32 s27, s89, 6
    v_xor_b32 v5, s27, v5
    v_add_u32 v8, v8, v5
    v_add_u32 v57, 65536, v8
    v_xor_b32 v58, 32, v57
    v_lshrrev_b32 v3, 4, v1
    v_bfe_u32 v4, v1, 2, 2
    v_lshlrev_b32 v8, 2, v3
    v_add_u32 v8, v8, v4
    v_lshlrev_b32 v8, 6, v8
    v_and_b32 v5, 3, v1
    v_lshlrev_b32 v5, 3, v5
    v_and_b32 v6, 1, v3
    v_lshlrev_b32 v6, 5, v6
    v_xor_b32 v5, v5, v6
    s_lshl_b32 s27, s89, 5
    v_xor_b32 v5, s27, v5
    v_add_u32 v8, v8, v5
    v_add_u32 v59, 90112, v8
    v_mov_b32 v64, 0
    v_mov_b32 v65, 0
    v_mov_b32 v66, 0
    v_mov_b32 v67, 0
    v_mov_b32 v68, 0
    v_mov_b32 v69, 0
    v_mov_b32 v70, 0
    v_mov_b32 v71, 0
    v_mov_b32 v72, 0
    v_mov_b32 v73, 0
    v_mov_b32 v74, 0
    v_mov_b32 v75, 0
    v_mov_b32 v76, 0
    v_mov_b32 v77, 0
    v_mov_b32 v78, 0
    v_mov_b32 v79, 0
    v_mov_b32 v80, 0
    v_mov_b32 v81, 0
    v_mov_b32 v82, 0
    v_mov_b32 v83, 0
    v_mov_b32 v84, 0
    v_mov_b32 v85, 0
    v_mov_b32 v86, 0
    v_mov_b32 v87, 0
    v_mov_b32 v88, 0
    v_mov_b32 v89, 0
    v_mov_b32 v90, 0
    v_mov_b32 v91, 0
    v_mov_b32 v92, 0
    v_mov_b32 v93, 0
    v_mov_b32 v94, 0
    v_mov_b32 v95, 0
    v_mov_b32 v96, 0
    v_mov_b32 v97, 0
    v_mov_b32 v98, 0
    v_mov_b32 v99, 0
    v_mov_b32 v100, 0
    v_mov_b32 v101, 0
    v_mov_b32 v102, 0
    v_mov_b32 v103, 0
    v_mov_b32 v104, 0
    v_mov_b32 v105, 0
    v_mov_b32 v106, 0
    v_mov_b32 v107, 0
    v_mov_b32 v108, 0
    v_mov_b32 v109, 0
    v_mov_b32 v110, 0
    v_mov_b32 v111, 0
    v_mov_b32 v112, 0
    v_mov_b32 v113, 0
    v_mov_b32 v114, 0
    v_mov_b32 v115, 0
    v_mov_b32 v116, 0
    v_mov_b32 v117, 0
    v_mov_b32 v118, 0
    v_mov_b32 v119, 0
    v_mov_b32 v120, 0
    v_mov_b32 v121, 0
    v_mov_b32 v122, 0
    v_mov_b32 v123, 0
    v_mov_b32 v124, 0
    v_mov_b32 v125, 0
    v_mov_b32 v126, 0
    v_mov_b32 v127, 0
    v_mov_b32 v128, 0
    v_mov_b32 v129, 0
    v_mov_b32 v130, 0
    v_mov_b32 v131, 0
    v_mov_b32 v132, 0
    v_mov_b32 v133, 0
    v_mov_b32 v134, 0
    v_mov_b32 v135, 0
    v_mov_b32 v136, 0
    v_mov_b32 v137, 0
    v_mov_b32 v138, 0
    v_mov_b32 v139, 0
    v_mov_b32 v140, 0
    v_mov_b32 v141, 0
    v_mov_b32 v142, 0
    v_mov_b32 v143, 0
    v_mov_b32 v144, 0
    v_mov_b32 v145, 0
    v_mov_b32 v146, 0
    v_mov_b32 v147, 0
    v_mov_b32 v148, 0
    v_mov_b32 v149, 0
    v_mov_b32 v150, 0
    v_mov_b32 v151, 0
    v_mov_b32 v152, 0
    v_mov_b32 v153, 0
    v_mov_b32 v154, 0
    v_mov_b32 v155, 0
    v_mov_b32 v156, 0
    v_mov_b32 v157, 0
    v_mov_b32 v158, 0
    v_mov_b32 v159, 0
    v_mov_b32 v160, 0
    v_mov_b32 v161, 0
    v_mov_b32 v162, 0
    v_mov_b32 v163, 0
    v_mov_b32 v164, 0
    v_mov_b32 v165, 0
    v_mov_b32 v166, 0
    v_mov_b32 v167, 0
    v_mov_b32 v168, 0
    v_mov_b32 v169, 0
    v_mov_b32 v170, 0
    v_mov_b32 v171, 0
    v_mov_b32 v172, 0
    v_mov_b32 v173, 0
    v_mov_b32 v174, 0
    v_mov_b32 v175, 0
    s_mov_b32 s31, 0
    s_mov_b32 s32, 0
    s_mov_b32 s30, 0
    v_add_u32 v60, s32, v56
    v_add_u32 v61, s31, v57
    v_add_u32 v62, s31, v58
    v_add_u32 v63, s31, v59
    s_barrier
    ds_read_b128 v[176:179], v60 offset:0
    ds_read_b64_tr_b16 v[20:21], v61 offset:0
    ds_read_b64_tr_b16 v[22:23], v61 offset:2048
    ds_read_b128 v[180:183], v60 offset:1024
    ds_read_b128 v[184:187], v60 offset:4096
    ds_read_b128 v[188:191], v60 offset:5120
    ds_read_b64_tr_b16 v[24:25], v62 offset:0
    ds_read_b64_tr_b16 v[26:27], v62 offset:2048
    ds_read_b64_tr_b16 v[28:29], v61 offset:8192
    ds_read_b64_tr_b16 v[30:31], v61 offset:10240
    ds_read_b64_tr_b16 v[32:33], v62 offset:8192
    ds_read_b64_tr_b16 v[34:35], v62 offset:10240
    ds_read_b64_tr_b16 v[36:37], v61 offset:16384
    ds_read_b64_tr_b16 v[38:39], v61 offset:18432
    ds_read_b64_tr_b16 v[40:41], v62 offset:16384
    ds_read_b64_tr_b16 v[42:43], v62 offset:18432
    ds_read_b64_tr_b16 v[44:45], v63 offset:0
    s_waitcnt lgkmcnt(3)
    v_mfma_f32_16x16x32_bf16 v[64:67], v[20:23], v[176:179], v[64:67]
    ds_read_b64_tr_b16 v[46:47], v63 offset:1024
    v_mfma_f32_16x16x32_bf16 v[72:75], v[20:23], v[180:183], v[72:75]
    ds_read_b128 v[192:195], v60 offset:2048
    v_mfma_f32_16x16x32_bf16 v[80:83], v[20:23], v[184:187], v[80:83]
    s_add_u32 s32, s32, 16384
    v_mfma_f32_16x16x32_bf16 v[88:91], v[20:23], v[188:191], v[88:91]
    ds_read_b64_tr_b16 v[20:21], v61 offset:4096
    v_mfma_f32_16x16x32_bf16 v[68:71], v[24:27], v[176:179], v[68:71]
    ds_read_b64_tr_b16 v[22:23], v61 offset:6144
    v_mfma_f32_16x16x32_bf16 v[76:79], v[24:27], v[180:183], v[76:79]
    ds_read_b128 v[196:199], v60 offset:3072
    v_mfma_f32_16x16x32_bf16 v[84:87], v[24:27], v[184:187], v[84:87]
    ds_read_b128 v[200:203], v60 offset:6144
    v_mfma_f32_16x16x32_bf16 v[92:95], v[24:27], v[188:191], v[92:95]
    ds_read_b128 v[204:207], v60 offset:7168
    v_mfma_f32_16x16x32_bf16 v[96:99], v[28:31], v[176:179], v[96:99]
    ds_read_b64_tr_b16 v[24:25], v62 offset:4096
    v_mfma_f32_16x16x32_bf16 v[104:107], v[28:31], v[180:183], v[104:107]
    ds_read_b64_tr_b16 v[26:27], v62 offset:6144
    v_mfma_f32_16x16x32_bf16 v[112:115], v[28:31], v[184:187], v[112:115]
    s_and_b32 s32, s32, 0xffff
    v_mfma_f32_16x16x32_bf16 v[120:123], v[28:31], v[188:191], v[120:123]
    ds_read_b64_tr_b16 v[28:29], v61 offset:12288
    v_mfma_f32_16x16x32_bf16 v[100:103], v[32:35], v[176:179], v[100:103]
    ds_read_b64_tr_b16 v[30:31], v61 offset:14336
    v_mfma_f32_16x16x32_bf16 v[108:111], v[32:35], v[180:183], v[108:111]
    s_add_u32 s31, s31, 28672
    v_mfma_f32_16x16x32_bf16 v[116:119], v[32:35], v[184:187], v[116:119]
    s_cmp_eq_u32 s31, 86016
    v_mfma_f32_16x16x32_bf16 v[124:127], v[32:35], v[188:191], v[124:127]
    ds_read_b64_tr_b16 v[32:33], v62 offset:12288
    v_mfma_f32_16x16x32_bf16 v[128:131], v[36:39], v[176:179], v[128:131]
    ds_read_b64_tr_b16 v[34:35], v62 offset:14336
    v_mfma_f32_16x16x32_bf16 v[136:139], v[36:39], v[180:183], v[136:139]
    s_cselect_b32 s31, 0, s31
    v_mfma_f32_16x16x32_bf16 v[144:147], v[36:39], v[184:187], v[144:147]
    s_add_u32 s30, s30, 1
    v_mfma_f32_16x16x32_bf16 v[152:155], v[36:39], v[188:191], v[152:155]
    ds_read_b64_tr_b16 v[36:37], v61 offset:20480
    s_waitcnt lgkmcnt(3)
    v_mfma_f32_16x16x32_bf16 v[132:135], v[40:43], v[176:179], v[132:135]
    ds_read_b64_tr_b16 v[38:39], v61 offset:22528
    v_mfma_f32_16x16x32_bf16 v[140:143], v[40:43], v[180:183], v[140:143]
    s_cmp_lt_u32 s30, 16
    v_mfma_f32_16x16x32_bf16 v[148:151], v[40:43], v[184:187], v[148:151]
    v_add_u32 v60, s32, v56
    v_mfma_f32_16x16x32_bf16 v[156:159], v[40:43], v[188:191], v[156:159]
    ds_read_b64_tr_b16 v[40:41], v62 offset:20480
    v_mfma_f32_16x16x32_bf16 v[160:163], v[44:47], v[176:179], v[160:163]
    ds_read_b64_tr_b16 v[42:43], v62 offset:22528
    v_mfma_f32_16x16x32_bf16 v[164:167], v[44:47], v[180:183], v[164:167]
    v_add_u32 v61, s31, v57
    v_mfma_f32_16x16x32_bf16 v[168:171], v[44:47], v[184:187], v[168:171]
    v_add_u32 v62, s31, v58
    v_mfma_f32_16x16x32_bf16 v[172:175], v[44:47], v[188:191], v[172:175]
    ds_read_b64_tr_b16 v[44:45], v63 offset:2048
    v_mfma_f32_16x16x32_bf16 v[64:67], v[20:23], v[192:195], v[64:67]
    ds_read_b64_tr_b16 v[46:47], v63 offset:3072
    v_mfma_f32_16x16x32_bf16 v[72:75], v[20:23], v[196:199], v[72:75]
    v_add_u32 v63, s31, v59
    v_mfma_f32_16x16x32_bf16 v[80:83], v[20:23], v[200:203], v[80:83]
    v_mfma_f32_16x16x32_bf16 v[88:91], v[20:23], v[204:207], v[88:91]
    v_mfma_f32_16x16x32_bf16 v[68:71], v[24:27], v[192:195], v[68:71]
    v_mfma_f32_16x16x32_bf16 v[76:79], v[24:27], v[196:199], v[76:79]
    v_mfma_f32_16x16x32_bf16 v[84:87], v[24:27], v[200:203], v[84:87]
    s_waitcnt lgkmcnt(0)
    v_mfma_f32_16x16x32_bf16 v[92:95], v[24:27], v[204:207], v[92:95]
    v_mfma_f32_16x16x32_bf16 v[96:99], v[28:31], v[192:195], v[96:99]
    v_mfma_f32_16x16x32_bf16 v[104:107], v[28:31], v[196:199], v[104:107]
    v_mfma_f32_16x16x32_bf16 v[112:115], v[28:31], v[200:203], v[112:115]
    v_mfma_f32_16x16x32_bf16 v[120:123], v[28:31], v[204:207], v[120:123]
    v_mfma_f32_16x16x32_bf16 v[100:103], v[32:35], v[192:195], v[100:103]
    v_mfma_f32_16x16x32_bf16 v[108:111], v[32:35], v[196:199], v[108:111]
    v_mfma_f32_16x16x32_bf16 v[116:119], v[32:35], v[200:203], v[116:119]
    v_mfma_f32_16x16x32_bf16 v[124:127], v[32:35], v[204:207], v[124:127]
    v_mfma_f32_16x16x32_bf16 v[128:131], v[36:39], v[192:195], v[128:131]
    v_mfma_f32_16x16x32_bf16 v[136:139], v[36:39], v[196:199], v[136:139]
    v_mfma_f32_16x16x32_bf16 v[144:147], v[36:39], v[200:203], v[144:147]
    v_mfma_f32_16x16x32_bf16 v[152:155], v[36:39], v[204:207], v[152:155]
    v_mfma_f32_16x16x32_bf16 v[132:135], v[40:43], v[192:195], v[132:135]
    v_mfma_f32_16x16x32_bf16 v[140:143], v[40:43], v[196:199], v[140:143]
    v_mfma_f32_16x16x32_bf16 v[148:151], v[40:43], v[200:203], v[148:151]
    v_mfma_f32_16x16x32_bf16 v[156:159], v[40:43], v[204:207], v[156:159]
    v_mfma_f32_16x16x32_bf16 v[160:163], v[44:47], v[192:195], v[160:163]
    v_mfma_f32_16x16x32_bf16 v[164:167], v[44:47], v[196:199], v[164:167]
    v_mfma_f32_16x16x32_bf16 v[168:171], v[44:47], v[200:203], v[168:171]
    v_mfma_f32_16x16x32_bf16 v[172:175], v[44:47], v[204:207], v[172:175]
    s_barrier
    ds_read_b128 v[176:179], v60 offset:0
    ds_read_b64_tr_b16 v[20:21], v61 offset:0
    ds_read_b64_tr_b16 v[22:23], v61 offset:2048
    ds_read_b128 v[180:183], v60 offset:1024
    ds_read_b128 v[184:187], v60 offset:4096
    ds_read_b128 v[188:191], v60 offset:5120
    ds_read_b64_tr_b16 v[24:25], v62 offset:0
    ds_read_b64_tr_b16 v[26:27], v62 offset:2048
    ds_read_b64_tr_b16 v[28:29], v61 offset:8192
    ds_read_b64_tr_b16 v[30:31], v61 offset:10240
    ds_read_b64_tr_b16 v[32:33], v62 offset:8192
    ds_read_b64_tr_b16 v[34:35], v62 offset:10240
    ds_read_b64_tr_b16 v[36:37], v61 offset:16384
    ds_read_b64_tr_b16 v[38:39], v61 offset:18432
    ds_read_b64_tr_b16 v[40:41], v62 offset:16384
    ds_read_b64_tr_b16 v[42:43], v62 offset:18432
    ds_read_b64_tr_b16 v[44:45], v63 offset:0
L_cons_47:
    s_waitcnt lgkmcnt(3)
    v_mfma_f32_16x16x32_bf16 v[64:67], v[20:23], v[176:179], v[64:67]
    ds_read_b64_tr_b16 v[46:47], v63 offset:1024
    v_mfma_f32_16x16x32_bf16 v[72:75], v[20:23], v[180:183], v[72:75]
    ds_read_b128 v[192:195], v60 offset:2048
    v_mfma_f32_16x16x32_bf16 v[80:83], v[20:23], v[184:187], v[80:83]
    s_add_u32 s32, s32, 16384
    v_mfma_f32_16x16x32_bf16 v[88:91], v[20:23], v[188:191], v[88:91]
    ds_read_b64_tr_b16 v[20:21], v61 offset:4096
    v_mfma_f32_16x16x32_bf16 v[68:71], v[24:27], v[176:179], v[68:71]
    ds_read_b64_tr_b16 v[22:23], v61 offset:6144
    v_mfma_f32_16x16x32_bf16 v[76:79], v[24:27], v[180:183], v[76:79]
    ds_read_b128 v[196:199], v60 offset:3072
    v_mfma_f32_16x16x32_bf16 v[84:87], v[24:27], v[184:187], v[84:87]
    ds_read_b128 v[200:203], v60 offset:6144
    v_mfma_f32_16x16x32_bf16 v[92:95], v[24:27], v[188:191], v[92:95]
    ds_read_b128 v[204:207], v60 offset:7168
    v_mfma_f32_16x16x32_bf16 v[96:99], v[28:31], v[176:179], v[96:99]
    ds_read_b64_tr_b16 v[24:25], v62 offset:4096
    v_mfma_f32_16x16x32_bf16 v[104:107], v[28:31], v[180:183], v[104:107]
    ds_read_b64_tr_b16 v[26:27], v62 offset:6144
    v_mfma_f32_16x16x32_bf16 v[112:115], v[28:31], v[184:187], v[112:115]
    s_and_b32 s32, s32, 0xffff
    v_mfma_f32_16x16x32_bf16 v[120:123], v[28:31], v[188:191], v[120:123]
    ds_read_b64_tr_b16 v[28:29], v61 offset:12288
    v_mfma_f32_16x16x32_bf16 v[100:103], v[32:35], v[176:179], v[100:103]
    ds_read_b64_tr_b16 v[30:31], v61 offset:14336
    v_mfma_f32_16x16x32_bf16 v[108:111], v[32:35], v[180:183], v[108:111]
    s_add_u32 s31, s31, 28672
    v_mfma_f32_16x16x32_bf16 v[116:119], v[32:35], v[184:187], v[116:119]
    s_cmp_eq_u32 s31, 86016
    v_mfma_f32_16x16x32_bf16 v[124:127], v[32:35], v[188:191], v[124:127]
    ds_read_b64_tr_b16 v[32:33], v62 offset:12288
    v_mfma_f32_16x16x32_bf16 v[128:131], v[36:39], v[176:179], v[128:131]
    ds_read_b64_tr_b16 v[34:35], v62 offset:14336
    v_mfma_f32_16x16x32_bf16 v[136:139], v[36:39], v[180:183], v[136:139]
    s_cselect_b32 s31, 0, s31
    v_mfma_f32_16x16x32_bf16 v[144:147], v[36:39], v[184:187], v[144:147]
    s_add_u32 s30, s30, 1
    v_mfma_f32_16x16x32_bf16 v[152:155], v[36:39], v[188:191], v[152:155]
    ds_read_b64_tr_b16 v[36:37], v61 offset:20480
    s_waitcnt lgkmcnt(3)
    v_mfma_f32_16x16x32_bf16 v[132:135], v[40:43], v[176:179], v[132:135]
    ds_read_b64_tr_b16 v[38:39], v61 offset:22528
    v_mfma_f32_16x16x32_bf16 v[140:143], v[40:43], v[180:183], v[140:143]
    s_cmp_lt_u32 s30, 16
    v_mfma_f32_16x16x32_bf16 v[148:151], v[40:43], v[184:187], v[148:151]
    v_add_u32 v60, s32, v56
    v_mfma_f32_16x16x32_bf16 v[156:159], v[40:43], v[188:191], v[156:159]
    ds_read_b64_tr_b16 v[40:41], v62 offset:20480
    v_mfma_f32_16x16x32_bf16 v[160:163], v[44:47], v[176:179], v[160:163]
    ds_read_b64_tr_b16 v[42:43], v62 offset:22528
    v_mfma_f32_16x16x32_bf16 v[164:167], v[44:47], v[180:183], v[164:167]
    v_add_u32 v61, s31, v57
    v_mfma_f32_16x16x32_bf16 v[168:171], v[44:47], v[184:187], v[168:171]
    v_add_u32 v62, s31, v58
    v_mfma_f32_16x16x32_bf16 v[172:175], v[44:47], v[188:191], v[172:175]
    ds_read_b64_tr_b16 v[44:45], v63 offset:2048
    v_mfma_f32_16x16x32_bf16 v[64:67], v[20:23], v[192:195], v[64:67]
    ds_read_b64_tr_b16 v[46:47], v63 offset:3072
    v_mfma_f32_16x16x32_bf16 v[72:75], v[20:23], v[196:199], v[72:75]
    v_add_u32 v63, s31, v59
    v_mfma_f32_16x16x32_bf16 v[80:83], v[20:23], v[200:203], v[80:83]
    v_mfma_f32_16x16x32_bf16 v[88:91], v[20:23], v[204:207], v[88:91]
    v_mfma_f32_16x16x32_bf16 v[68:71], v[24:27], v[192:195], v[68:71]
    v_mfma_f32_16x16x32_bf16 v[76:79], v[24:27], v[196:199], v[76:79]
    v_mfma_f32_16x16x32_bf16 v[84:87], v[24:27], v[200:203], v[84:87]
    s_waitcnt lgkmcnt(0)
    s_barrier
    v_mfma_f32_16x16x32_bf16 v[92:95], v[24:27], v[204:207], v[92:95]
    ds_read_b128 v[176:179], v60 offset:0
    ds_read_b64_tr_b16 v[20:21], v61 offset:0
    v_mfma_f32_16x16x32_bf16 v[96:99], v[28:31], v[192:195], v[96:99]
    ds_read_b64_tr_b16 v[22:23], v61 offset:2048
    v_mfma_f32_16x16x32_bf16 v[104:107], v[28:31], v[196:199], v[104:107]
    ds_read_b128 v[180:183], v60 offset:1024
    v_mfma_f32_16x16x32_bf16 v[112:115], v[28:31], v[200:203], v[112:115]
    ds_read_b128 v[184:187], v60 offset:4096
    v_mfma_f32_16x16x32_bf16 v[120:123], v[28:31], v[204:207], v[120:123]
    ds_read_b128 v[188:191], v60 offset:5120
    v_mfma_f32_16x16x32_bf16 v[100:103], v[32:35], v[192:195], v[100:103]
    ds_read_b64_tr_b16 v[24:25], v62 offset:0
    v_mfma_f32_16x16x32_bf16 v[108:111], v[32:35], v[196:199], v[108:111]
    ds_read_b64_tr_b16 v[26:27], v62 offset:2048
    v_mfma_f32_16x16x32_bf16 v[116:119], v[32:35], v[200:203], v[116:119]
    ds_read_b64_tr_b16 v[28:29], v61 offset:8192
    v_mfma_f32_16x16x32_bf16 v[124:127], v[32:35], v[204:207], v[124:127]
    ds_read_b64_tr_b16 v[30:31], v61 offset:10240
    v_mfma_f32_16x16x32_bf16 v[128:131], v[36:39], v[192:195], v[128:131]
    ds_read_b64_tr_b16 v[32:33], v62 offset:8192
    v_mfma_f32_16x16x32_bf16 v[136:139], v[36:39], v[196:199], v[136:139]
    ds_read_b64_tr_b16 v[34:35], v62 offset:10240
    v_mfma_f32_16x16x32_bf16 v[144:147], v[36:39], v[200:203], v[144:147]
    v_mfma_f32_16x16x32_bf16 v[152:155], v[36:39], v[204:207], v[152:155]
    ds_read_b64_tr_b16 v[36:37], v61 offset:16384
    v_mfma_f32_16x16x32_bf16 v[132:135], v[40:43], v[192:195], v[132:135]
    ds_read_b64_tr_b16 v[38:39], v61 offset:18432
    v_mfma_f32_16x16x32_bf16 v[140:143], v[40:43], v[196:199], v[140:143]
    v_mfma_f32_16x16x32_bf16 v[148:151], v[40:43], v[200:203], v[148:151]
    v_mfma_f32_16x16x32_bf16 v[156:159], v[40:43], v[204:207], v[156:159]
    ds_read_b64_tr_b16 v[40:41], v62 offset:16384
    v_mfma_f32_16x16x32_bf16 v[160:163], v[44:47], v[192:195], v[160:163]
    ds_read_b64_tr_b16 v[42:43], v62 offset:18432
    v_mfma_f32_16x16x32_bf16 v[164:167], v[44:47], v[196:199], v[164:167]
    v_mfma_f32_16x16x32_bf16 v[168:171], v[44:47], v[200:203], v[168:171]
    v_mfma_f32_16x16x32_bf16 v[172:175], v[44:47], v[204:207], v[172:175]
    ds_read_b64_tr_b16 v[44:45], v63 offset:0
    s_cbranch_scc1 L_cons_47
    s_waitcnt lgkmcnt(0)
    s_lshl_b32 s27, s88, 8
    s_add_u32 s27, s27, 159744
    v_and_b32 v3, 15, v1
    v_lshlrev_b32 v4, 2, v3
    v_add_u32 v5, s27, v4
    v_lshrrev_b32 v6, 4, v1
    v_lshlrev_b32 v7, 4, v6
    s_lshl_b32 s28, s89, 7
    s_add_u32 s28, s28, 160768
    v_add_u32 v8, s28, v7
    s_lshl_b32 s28, s89, 6
    s_add_u32 s28, s28, 161536
    v_add_u32 v7, s28, v7
    ds_read_b32 v20, v5 offset:0
    ds_read_b32 v22, v5 offset:64
    ds_read_b32 v24, v5 offset:128
    ds_read_b32 v26, v5 offset:192
    ds_read_b128 v[176:179], v8 offset:0
    ds_read_b128 v[180:183], v8 offset:64
    ds_read_b128 v[184:187], v8 offset:256
    ds_read_b128 v[188:191], v8 offset:320
    ds_read_b128 v[192:195], v8 offset:512
    ds_read_b128 v[196:199], v8 offset:576
    ds_read_b128 v[200:203], v7
    ds_read_b32 v216, v5 offset:512
    ds_read_b32 v218, v5 offset:576
    ds_read_b32 v220, v5 offset:640
    ds_read_b32 v222, v5 offset:704
    s_lshl_b32 s47, s6, 1
    s_mul_i32 s27, s47, 229376
    s_add_u32 s27, s27, 0x100000
    s_add_u32 s32, s51, s89
    s_lshl_b32 s32, s32, 11
    s_add_u32 s32, s32, s27
    s_add_u32 s33, s32, 229376
    s_lshl_b32 s34, s50, 11
    s_add_u32 s34, s34, s27
    s_lshl_b32 s28, s89, 9
    s_add_u32 s34, s34, s28
    s_add_u32 s35, s34, 229376
    v_and_b32 v9, 1, v6
    v_lshlrev_b32 v9, 10, v9
    v_lshrrev_b32 v6, 1, v6
    v_lshlrev_b32 v6, 8, v6
    v_lshlrev_b32 v3, 4, v3
    v_add3_u32 v9, v9, v6, v3
    s_lshl_b32 s27, s88, 13
    s_lshl_b32 s28, s89, 11
    s_add_u32 s27, s27, s28
    s_add_u32 s27, s27, 65536
    v_add_u32 v10, s27, v2
    s_waitcnt lgkmcnt(9)
    v_pk_fma_f32 v[64:65], v[176:177], v[20:21], v[64:65] op_sel_hi:[1,0,1]
    v_pk_fma_f32 v[66:67], v[178:179], v[20:21], v[66:67] op_sel_hi:[1,0,1]
    v_pk_fma_f32 v[68:69], v[180:181], v[20:21], v[68:69] op_sel_hi:[1,0,1]
    v_pk_fma_f32 v[70:71], v[182:183], v[20:21], v[70:71] op_sel_hi:[1,0,1]
    v_cvt_pk_bf16_f32 v64, v64, v65
    v_cvt_pk_bf16_f32 v65, v66, v67
    v_cvt_pk_bf16_f32 v66, v68, v69
    v_cvt_pk_bf16_f32 v67, v70, v71
    v_pk_max_i16 v64, v64, 0
    v_pk_max_i16 v65, v65, 0
    v_pk_max_i16 v66, v66, 0
    v_pk_max_i16 v67, v67, 0
    buffer_store_dwordx4 v[64:67], v2, s[8:11], s32 offen offset:0 sc1
    ds_write_b128 v10, v[64:67] offset:0
    v_pk_fma_f32 v[72:73], v[176:177], v[22:23], v[72:73] op_sel_hi:[1,0,1]
    v_pk_fma_f32 v[74:75], v[178:179], v[22:23], v[74:75] op_sel_hi:[1,0,1]
    v_pk_fma_f32 v[76:77], v[180:181], v[22:23], v[76:77] op_sel_hi:[1,0,1]
    v_pk_fma_f32 v[78:79], v[182:183], v[22:23], v[78:79] op_sel_hi:[1,0,1]
    v_cvt_pk_bf16_f32 v72, v72, v73
    v_cvt_pk_bf16_f32 v73, v74, v75
    v_cvt_pk_bf16_f32 v74, v76, v77
    v_cvt_pk_bf16_f32 v75, v78, v79
    v_pk_max_i16 v72, v72, 0
    v_pk_max_i16 v73, v73, 0
    v_pk_max_i16 v74, v74, 0
    v_pk_max_i16 v75, v75, 0
    buffer_store_dwordx4 v[72:75], v2, s[8:11], s32 offen offset:1024 sc1
    ds_write_b128 v10, v[72:75] offset:1024
    v_pk_fma_f32 v[80:81], v[176:177], v[24:25], v[80:81] op_sel_hi:[1,0,1]
    v_pk_fma_f32 v[82:83], v[178:179], v[24:25], v[82:83] op_sel_hi:[1,0,1]
    v_pk_fma_f32 v[84:85], v[180:181], v[24:25], v[84:85] op_sel_hi:[1,0,1]
    v_pk_fma_f32 v[86:87], v[182:183], v[24:25], v[86:87] op_sel_hi:[1,0,1]
    v_cvt_pk_bf16_f32 v80, v80, v81
    v_cvt_pk_bf16_f32 v81, v82, v83
    v_cvt_pk_bf16_f32 v82, v84, v85
    v_cvt_pk_bf16_f32 v83, v86, v87
    v_pk_max_i16 v80, v80, 0
    v_pk_max_i16 v81, v81, 0
    v_pk_max_i16 v82, v82, 0
    v_pk_max_i16 v83, v83, 0
    buffer_store_dwordx4 v[80:83], v2, s[8:11], s33 offen offset:0 sc1
    ds_write_b128 v10, v[80:83] offset:4096
    v_pk_fma_f32 v[88:89], v[176:177], v[26:27], v[88:89] op_sel_hi:[1,0,1]
    v_pk_fma_f32 v[90:91], v[178:179], v[26:27], v[90:91] op_sel_hi:[1,0,1]
    v_pk_fma_f32 v[92:93], v[180:181], v[26:27], v[92:93] op_sel_hi:[1,0,1]
    v_pk_fma_f32 v[94:95], v[182:183], v[26:27], v[94:95] op_sel_hi:[1,0,1]
    v_cvt_pk_bf16_f32 v88, v88, v89
    v_cvt_pk_bf16_f32 v89, v90, v91
    v_cvt_pk_bf16_f32 v90, v92, v93
    v_cvt_pk_bf16_f32 v91, v94, v95
    v_pk_max_i16 v88, v88, 0
    v_pk_max_i16 v89, v89, 0
    v_pk_max_i16 v90, v90, 0
    v_pk_max_i16 v91, v91, 0
    buffer_store_dwordx4 v[88:91], v2, s[8:11], s33 offen offset:1024 sc1
    ds_write_b128 v10, v[88:91] offset:5120
    s_add_u32 s32, s32, 4096
    s_add_u32 s33, s33, 4096
    s_waitcnt lgkmcnt(4)
    v_pk_fma_f32 v[96:97], v[184:185], v[20:21], v[96:97] op_sel_hi:[1,0,1]
    v_pk_fma_f32 v[98:99], v[186:187], v[20:21], v[98:99] op_sel_hi:[1,0,1]
    v_pk_fma_f32 v[100:101], v[188:189], v[20:21], v[100:101] op_sel_hi:[1,0,1]
    v_pk_fma_f32 v[102:103], v[190:191], v[20:21], v[102:103] op_sel_hi:[1,0,1]
    v_cvt_pk_bf16_f32 v96, v96, v97
    v_cvt_pk_bf16_f32 v97, v98, v99
    v_cvt_pk_bf16_f32 v98, v100, v101
    v_cvt_pk_bf16_f32 v99, v102, v103
    v_pk_max_i16 v96, v96, 0
    v_pk_max_i16 v97, v97, 0
    v_pk_max_i16 v98, v98, 0
    v_pk_max_i16 v99, v99, 0
    buffer_store_dwordx4 v[96:99], v2, s[8:11], s32 offen offset:0 sc1
    ds_write_b128 v10, v[96:99] offset:16384
    v_pk_fma_f32 v[104:105], v[184:185], v[22:23], v[104:105] op_sel_hi:[1,0,1]
    v_pk_fma_f32 v[106:107], v[186:187], v[22:23], v[106:107] op_sel_hi:[1,0,1]
    v_pk_fma_f32 v[108:109], v[188:189], v[22:23], v[108:109] op_sel_hi:[1,0,1]
    v_pk_fma_f32 v[110:111], v[190:191], v[22:23], v[110:111] op_sel_hi:[1,0,1]
    v_cvt_pk_bf16_f32 v104, v104, v105
    v_cvt_pk_bf16_f32 v105, v106, v107
    v_cvt_pk_bf16_f32 v106, v108, v109
    v_cvt_pk_bf16_f32 v107, v110, v111
    v_pk_max_i16 v104, v104, 0
    v_pk_max_i16 v105, v105, 0
    v_pk_max_i16 v106, v106, 0
    v_pk_max_i16 v107, v107, 0
    buffer_store_dwordx4 v[104:107], v2, s[8:11], s32 offen offset:1024 sc1
    ds_write_b128 v10, v[104:107] offset:17408
    v_pk_fma_f32 v[112:113], v[184:185], v[24:25], v[112:113] op_sel_hi:[1,0,1]
    v_pk_fma_f32 v[114:115], v[186:187], v[24:25], v[114:115] op_sel_hi:[1,0,1]
    v_pk_fma_f32 v[116:117], v[188:189], v[24:25], v[116:117] op_sel_hi:[1,0,1]
    v_pk_fma_f32 v[118:119], v[190:191], v[24:25], v[118:119] op_sel_hi:[1,0,1]
    v_cvt_pk_bf16_f32 v112, v112, v113
    v_cvt_pk_bf16_f32 v113, v114, v115
    v_cvt_pk_bf16_f32 v114, v116, v117
    v_cvt_pk_bf16_f32 v115, v118, v119
    v_pk_max_i16 v112, v112, 0
    v_pk_max_i16 v113, v113, 0
    v_pk_max_i16 v114, v114, 0
    v_pk_max_i16 v115, v115, 0
    buffer_store_dwordx4 v[112:115], v2, s[8:11], s33 offen offset:0 sc1
    ds_write_b128 v10, v[112:115] offset:20480
    v_pk_fma_f32 v[120:121], v[184:185], v[26:27], v[120:121] op_sel_hi:[1,0,1]
    v_pk_fma_f32 v[122:123], v[186:187], v[26:27], v[122:123] op_sel_hi:[1,0,1]
    v_pk_fma_f32 v[124:125], v[188:189], v[26:27], v[124:125] op_sel_hi:[1,0,1]
    v_pk_fma_f32 v[126:127], v[190:191], v[26:27], v[126:127] op_sel_hi:[1,0,1]
    v_cvt_pk_bf16_f32 v120, v120, v121
    v_cvt_pk_bf16_f32 v121, v122, v123
    v_cvt_pk_bf16_f32 v122, v124, v125
    v_cvt_pk_bf16_f32 v123, v126, v127
    v_pk_max_i16 v120, v120, 0
    v_pk_max_i16 v121, v121, 0
    v_pk_max_i16 v122, v122, 0
    v_pk_max_i16 v123, v123, 0
    buffer_store_dwordx4 v[120:123], v2, s[8:11], s33 offen offset:1024 sc1
    ds_write_b128 v10, v[120:123] offset:21504
    s_add_u32 s32, s32, 4096
    s_add_u32 s33, s33, 4096
    s_add_u32 s29, s6, 32
    s_lshl_b32 s27, s29, 9
    s_lshl_b32 s28, s7, 4
    s_add_u32 s27, s27, s28
    s_add_u32 s27, s27, 0x19c0000
    v_mov_b32 v4, 0
    v_mov_b32 v5, s78
    s_waitcnt vmcnt(4)
    s_mov_b64 exec, 1
    buffer_store_dword v5, v4, s[8:11], s27 offen sc1
    s_mov_b64 exec, -1
    s_waitcnt lgkmcnt(4)
    v_pk_fma_f32 v[128:129], v[192:193], v[20:21], v[128:129] op_sel_hi:[1,0,1]
    v_pk_fma_f32 v[130:131], v[194:195], v[20:21], v[130:131] op_sel_hi:[1,0,1]
    v_pk_fma_f32 v[132:133], v[196:197], v[20:21], v[132:133] op_sel_hi:[1,0,1]
    v_pk_fma_f32 v[134:135], v[198:199], v[20:21], v[134:135] op_sel_hi:[1,0,1]
    v_cvt_pk_bf16_f32 v128, v128, v129
    v_cvt_pk_bf16_f32 v129, v130, v131
    v_cvt_pk_bf16_f32 v130, v132, v133
    v_cvt_pk_bf16_f32 v131, v134, v135
    v_pk_max_i16 v128, v128, 0
    v_pk_max_i16 v129, v129, 0
    v_pk_max_i16 v130, v130, 0
    v_pk_max_i16 v131, v131, 0
    buffer_store_dwordx4 v[128:131], v2, s[8:11], s32 offen offset:0 sc1
    ds_write_b128 v10, v[128:131] offset:32768
    v_pk_fma_f32 v[136:137], v[192:193], v[22:23], v[136:137] op_sel_hi:[1,0,1]
    v_pk_fma_f32 v[138:139], v[194:195], v[22:23], v[138:139] op_sel_hi:[1,0,1]
    v_pk_fma_f32 v[140:141], v[196:197], v[22:23], v[140:141] op_sel_hi:[1,0,1]
    v_pk_fma_f32 v[142:143], v[198:199], v[22:23], v[142:143] op_sel_hi:[1,0,1]
    v_cvt_pk_bf16_f32 v136, v136, v137
    v_cvt_pk_bf16_f32 v137, v138, v139
    v_cvt_pk_bf16_f32 v138, v140, v141
    v_cvt_pk_bf16_f32 v139, v142, v143
    v_pk_max_i16 v136, v136, 0
    v_pk_max_i16 v137, v137, 0
    v_pk_max_i16 v138, v138, 0
    v_pk_max_i16 v139, v139, 0
    buffer_store_dwordx4 v[136:139], v2, s[8:11], s32 offen offset:1024 sc1
    ds_write_b128 v10, v[136:139] offset:33792
    v_pk_fma_f32 v[144:145], v[192:193], v[24:25], v[144:145] op_sel_hi:[1,0,1]
    v_pk_fma_f32 v[146:147], v[194:195], v[24:25], v[146:147] op_sel_hi:[1,0,1]
    v_pk_fma_f32 v[148:149], v[196:197], v[24:25], v[148:149] op_sel_hi:[1,0,1]
    v_pk_fma_f32 v[150:151], v[198:199], v[24:25], v[150:151] op_sel_hi:[1,0,1]
    v_cvt_pk_bf16_f32 v144, v144, v145
    v_cvt_pk_bf16_f32 v145, v146, v147
    v_cvt_pk_bf16_f32 v146, v148, v149
    v_cvt_pk_bf16_f32 v147, v150, v151
    v_pk_max_i16 v144, v144, 0
    v_pk_max_i16 v145, v145, 0
    v_pk_max_i16 v146, v146, 0
    v_pk_max_i16 v147, v147, 0
    buffer_store_dwordx4 v[144:147], v2, s[8:11], s33 offen offset:0 sc1
    ds_write_b128 v10, v[144:147] offset:36864
    v_pk_fma_f32 v[152:153], v[192:193], v[26:27], v[152:153] op_sel_hi:[1,0,1]
    v_pk_fma_f32 v[154:155], v[194:195], v[26:27], v[154:155] op_sel_hi:[1,0,1]
    v_pk_fma_f32 v[156:157], v[196:197], v[26:27], v[156:157] op_sel_hi:[1,0,1]
    v_pk_fma_f32 v[158:159], v[198:199], v[26:27], v[158:159] op_sel_hi:[1,0,1]
    v_cvt_pk_bf16_f32 v152, v152, v153
    v_cvt_pk_bf16_f32 v153, v154, v155
    v_cvt_pk_bf16_f32 v154, v156, v157
    v_cvt_pk_bf16_f32 v155, v158, v159
    v_pk_max_i16 v152, v152, 0
    v_pk_max_i16 v153, v153, 0
    v_pk_max_i16 v154, v154, 0
    v_pk_max_i16 v155, v155, 0
    buffer_store_dwordx4 v[152:155], v2, s[8:11], s33 offen offset:1024 sc1
    ds_write_b128 v10, v[152:155] offset:37888
    v_pk_fma_f32 v[160:161], v[200:201], v[20:21], v[160:161] op_sel_hi:[1,0,1]
    v_pk_fma_f32 v[162:163], v[202:203], v[20:21], v[162:163] op_sel_hi:[1,0,1]
    v_pk_fma_f32 v[164:165], v[200:201], v[22:23], v[164:165] op_sel_hi:[1,0,1]
    v_pk_fma_f32 v[166:167], v[202:203], v[22:23], v[166:167] op_sel_hi:[1,0,1]
    v_cvt_pk_bf16_f32 v160, v160, v161
    v_cvt_pk_bf16_f32 v161, v162, v163
    v_cvt_pk_bf16_f32 v162, v164, v165
    v_cvt_pk_bf16_f32 v163, v166, v167
    v_pk_max_i16 v160, v160, 0
    v_pk_max_i16 v161, v161, 0
    v_pk_max_i16 v162, v162, 0
    v_pk_max_i16 v163, v163, 0
    v_rcp_f32 v217, v216
    v_rcp_f32 v219, v218
    v_permlane16_swap_b32 v160, v162
    v_permlane16_swap_b32 v161, v163
    buffer_store_dwordx4 v[160:163], v9, s[8:11], s34 offen sc1
    v_pk_fma_f32 v[168:169], v[200:201], v[24:25], v[168:169] op_sel_hi:[1,0,1]
    v_pk_fma_f32 v[170:171], v[202:203], v[24:25], v[170:171] op_sel_hi:[1,0,1]
    v_pk_fma_f32 v[172:173], v[200:201], v[26:27], v[172:173] op_sel_hi:[1,0,1]
    v_pk_fma_f32 v[174:175], v[202:203], v[26:27], v[174:175] op_sel_hi:[1,0,1]
    v_cvt_pk_bf16_f32 v168, v168, v169
    v_cvt_pk_bf16_f32 v169, v170, v171
    v_cvt_pk_bf16_f32 v170, v172, v173
    v_cvt_pk_bf16_f32 v171, v174, v175
    v_pk_max_i16 v168, v168, 0
    v_pk_max_i16 v169, v169, 0
    v_pk_max_i16 v170, v170, 0
    v_pk_max_i16 v171, v171, 0
    v_rcp_f32 v221, v220
    v_rcp_f32 v223, v222
    v_permlane16_swap_b32 v168, v170
    v_permlane16_swap_b32 v169, v171
    buffer_store_dwordx4 v[168:171], v9, s[8:11], s35 offen sc1
    s_waitcnt lgkmcnt(0)
    s_setprio 0
L_f1_done:
    s_cmp_ge_u32 s22, 4
    s_cbranch_scc0 L_f2_cons
    s_sub_u32 s26, s22, 4
    s_lshl_b32 s24, s20, 2
    s_add_u32 s24, s24, s26
    s_lshl_b32 s38, s26, 12
    s_lshl_b32 s39, s26, 11
    s_lshl_b32 s40, s26, 10
    s_mul_i32 s27, s24, 229376
    s_add_u32 s27, s27, 0x100000
    v_add_u32 v192, s27, v2
    v_add_u32 v197, 0, v192
    s_mov_b32 s37, 49152
    s_and_b32 s36, s21, 1
    s_lshl_b32 s36, s36, 2
    s_add_u32 s46, s36, 56
    s_lshr_b32 s47, s51, 1
    s_cmp_eq_u32 s36, s47
    s_cselect_b32 s27, 7, 0
    s_add_u32 s36, s36, s27
    s_lshr_b32 s29, s24, 1
    s_lshl_b32 s43, s29, 9
    s_add_u32 s43, s43, 0x19c0000
    s_add_u32 s25, s43, 16384
    v_bfe_u32 v8, v1, 1, 1
    s_and_b32 s27, s21, 1
    v_cmp_eq_u32 s[60:61], s27, v8
    s_waitcnt vmcnt(8)
    s_barrier
    s_mov_b32 s42, s36
    s_add_u32 s33, s37, s39
    s_add_u32 m0, s33, 0
    s_lshl_b32 s27, s36, s44
    buffer_load_dwordx4 v193, s[12:15], s27 offen sc1 lds
    buffer_load_dwordx4 v194, s[12:15], s27 offen offset:1024 sc1 lds
    s_add_u32 m0, s33, 8192
    s_lshl_b32 s27, s36, s48
    buffer_load_dwordx4 v195, s[64:67], s27 offen sc1 lds
    buffer_load_dwordx4 v196, s[64:67], s27 offen offset:1024 sc1 lds
    s_add_u32 s37, s37, 16384
    s_and_b32 s37, s37, 0xffff
    s_add_u32 s36, s36, 7
    s_cmp_eq_u32 s36, s47
    s_cselect_b32 s27, 7, 0
    s_add_u32 s36, s36, s27
    s_cmp_eq_u32 s36, s46
    s_cselect_b32 s27, 55, 0
    s_cselect_b32 s28, 1, 0
    s_sub_u32 s36, s36, s27
    s_add_u32 s46, s46, s28
    s_add_u32 s47, s47, s28
    s_cmp_eq_u32 s36, s47
    s_cselect_b32 s27, 7, 0
    s_add_u32 s36, s36, s27
    s_waitcnt vmcnt(8)
    s_barrier
    s_mov_b32 s45, s36
    v_and_b32 v8, 31, v1
    v_lshlrev_b32 v8, 4, v8
    buffer_load_dword v16, v8, s[8:11], s25 offen sc1
    s_add_u32 s33, s37, s39
    s_add_u32 m0, s33, 0
    s_lshl_b32 s27, s36, s44
    buffer_load_dwordx4 v193, s[12:15], s27 offen sc1 lds
    buffer_load_dwordx4 v194, s[12:15], s27 offen offset:1024 sc1 lds
    s_add_u32 m0, s33, 8192
    s_lshl_b32 s27, s36, s48
    buffer_load_dwordx4 v195, s[64:67], s27 offen sc1 lds
    buffer_load_dwordx4 v196, s[64:67], s27 offen offset:1024 sc1 lds
    s_add_u32 s37, s37, 16384
    s_and_b32 s37, s37, 0xffff
    s_add_u32 s36, s36, 7
    s_cmp_eq_u32 s36, s47
    s_cselect_b32 s27, 7, 0
    s_add_u32 s36, s36, s27
    s_cmp_eq_u32 s36, s46
    s_cselect_b32 s27, 55, 0
    s_cselect_b32 s28, 1, 0
    s_sub_u32 s36, s36, s27
    s_add_u32 s46, s46, s28
    s_add_u32 s47, s47, s28
    s_cmp_eq_u32 s36, s47
    s_cselect_b32 s27, 7, 0
    s_add_u32 s36, s36, s27
    s_waitcnt vmcnt(4)
    s_barrier
    s_mov_b64 exec, s[60:61]
    v_cmp_ne_u32 vcc, s78, v16
    s_cbranch_vccz L_hb_48
    v_and_b32 v8, 31, v1
    v_lshlrev_b32 v8, 4, v8
    s_mov_b32 s27, 0
L_poll_49:
    buffer_load_dword v9, v8, s[8:11], s25 offen sc1
    s_add_u32 s27, s27, 1
    s_waitcnt vmcnt(0)
    v_cmp_ne_u32 vcc, s78, v9
    s_cbranch_vccz L_pd_50
    s_sleep 1
    s_cmp_lt_u32 s27, 0x40000
    s_cbranch_scc1 L_poll_49
L_pd_50:
L_hb_48:
    s_mov_b64 exec, -1
    s_lshl_b32 s35, s42, 12
    s_add_u32 s33, 49152, s38
    s_add_u32 m0, s33, 65536
    s_nop 0
    buffer_load_dwordx4 v192, s[8:11], s35 offen offset:0 sc1 lds
    buffer_load_dwordx4 v192, s[8:11], s35 offen offset:1024 sc1 lds
    buffer_load_dwordx4 v197, s[8:11], s35 offen offset:2048 sc1 lds
    buffer_load_dwordx4 v197, s[8:11], s35 offen offset:3072 sc1 lds
    s_lshl_b32 s35, s45, 12
    s_add_u32 s33, 0, s38
    s_add_u32 m0, s33, 65536
    s_nop 0
    buffer_load_dwordx4 v192, s[8:11], s35 offen offset:0 sc1 lds
    buffer_load_dwordx4 v192, s[8:11], s35 offen offset:1024 sc1 lds
    buffer_load_dwordx4 v197, s[8:11], s35 offen offset:2048 sc1 lds
    buffer_load_dwordx4 v197, s[8:11], s35 offen offset:3072 sc1 lds
    s_lshl_b32 s35, s36, 12
    s_add_u32 s33, s37, s38
    s_add_u32 m0, s33, 65536
    s_nop 0
    buffer_load_dwordx4 v192, s[8:11], s35 offen offset:0 sc1 lds
    buffer_load_dwordx4 v192, s[8:11], s35 offen offset:1024 sc1 lds
    buffer_load_dwordx4 v197, s[8:11], s35 offen offset:2048 sc1 lds
    buffer_load_dwordx4 v197, s[8:11], s35 offen offset:3072 sc1 lds
    s_add_u32 s33, s37, s39
    s_add_u32 m0, s33, 0
    s_lshl_b32 s27, s36, s44
    buffer_load_dwordx4 v193, s[12:15], s27 offen sc1 lds
    buffer_load_dwordx4 v194, s[12:15], s27 offen offset:1024 sc1 lds
    s_add_u32 m0, s33, 8192
    s_lshl_b32 s27, s36, s48
    buffer_load_dwordx4 v195, s[64:67], s27 offen sc1 lds
    buffer_load_dwordx4 v196, s[64:67], s27 offen offset:1024 sc1 lds
    s_add_u32 s37, s37, 16384
    s_and_b32 s37, s37, 0xffff
    s_add_u32 s36, s36, 7
    s_cmp_eq_u32 s36, s47
    s_cselect_b32 s27, 7, 0
    s_add_u32 s36, s36, s27
    s_cmp_eq_u32 s36, s46
    s_cselect_b32 s27, 55, 0
    s_cselect_b32 s28, 1, 0
    s_sub_u32 s36, s36, s27
    s_add_u32 s46, s46, s28
    s_add_u32 s47, s47, s28
    s_cmp_eq_u32 s36, s47
    s_cselect_b32 s27, 7, 0
    s_add_u32 s36, s36, s27
    s_waitcnt vmcnt(12)
    s_barrier
    s_lshl_b32 s35, s36, 12
    s_add_u32 s33, s37, s38
    s_add_u32 m0, s33, 65536
    s_nop 0
    buffer_load_dwordx4 v192, s[8:11], s35 offen offset:0 sc1 lds
    buffer_load_dwordx4 v192, s[8:11], s35 offen offset:1024 sc1 lds
    buffer_load_dwordx4 v197, s[8:11], s35 offen offset:2048 sc1 lds
    buffer_load_dwordx4 v197, s[8:11], s35 offen offset:3072 sc1 lds
    s_add_u32 s33, s37, s39
    s_add_u32 m0, s33, 0
    s_lshl_b32 s27, s36, s44
    buffer_load_dwordx4 v193, s[12:15], s27 offen sc1 lds
    buffer_load_dwordx4 v194, s[12:15], s27 offen offset:1024 sc1 lds
    s_add_u32 m0, s33, 8192
    s_lshl_b32 s27, s36, s48
    buffer_load_dwordx4 v195, s[64:67], s27 offen sc1 lds
    buffer_load_dwordx4 v196, s[64:67], s27 offen offset:1024 sc1 lds
    s_add_u32 s37, s37, 16384
    s_and_b32 s37, s37, 0xffff
    s_add_u32 s36, s36, 7
    s_cmp_eq_u32 s36, s47
    s_cselect_b32 s27, 7, 0
    s_add_u32 s36, s36, s27
    s_cmp_eq_u32 s36, s46
    s_cselect_b32 s27, 55, 0
    s_cselect_b32 s28, 1, 0
    s_sub_u32 s36, s36, s27
    s_add_u32 s46, s46, s28
    s_add_u32 s47, s47, s28
    s_cmp_eq_u32 s36, s47
    s_cselect_b32 s27, 7, 0
    s_add_u32 s36, s36, s27
    s_waitcnt vmcnt(16)
    s_barrier
    s_lshl_b32 s35, s36, 12
    s_add_u32 s33, s37, s38
    s_add_u32 m0, s33, 65536
    s_nop 0
    buffer_load_dwordx4 v192, s[8:11], s35 offen offset:0 sc1 lds
    buffer_load_dwordx4 v192, s[8:11], s35 offen offset:1024 sc1 lds
    buffer_load_dwordx4 v197, s[8:11], s35 offen offset:2048 sc1 lds
    buffer_load_dwordx4 v197, s[8:11], s35 offen offset:3072 sc1 lds
    s_add_u32 s33, s37, s39
    s_add_u32 m0, s33, 0
    s_lshl_b32 s27, s36, s44
    buffer_load_dwordx4 v193, s[12:15], s27 offen sc1 lds
    buffer_load_dwordx4 v194, s[12:15], s27 offen offset:1024 sc1 lds
    s_add_u32 m0, s33, 8192
    s_lshl_b32 s27, s36, s48
    buffer_load_dwordx4 v195, s[64:67], s27 offen sc1 lds
    buffer_load_dwordx4 v196, s[64:67], s27 offen offset:1024 sc1 lds
    s_add_u32 s37, s37, 16384
    s_and_b32 s37, s37, 0xffff
    s_add_u32 s36, s36, 7
    s_cmp_eq_u32 s36, s47
    s_cselect_b32 s27, 7, 0
    s_add_u32 s36, s36, s27
    s_cmp_eq_u32 s36, s46
    s_cselect_b32 s27, 55, 0
    s_cselect_b32 s28, 1, 0
    s_sub_u32 s36, s36, s27
    s_add_u32 s46, s46, s28
    s_add_u32 s47, s47, s28
    s_cmp_eq_u32 s36, s47
    s_cselect_b32 s27, 7, 0
    s_add_u32 s36, s36, s27
    s_waitcnt vmcnt(16)
    s_barrier
    v_and_b32 v8, 31, v1
    v_lshlrev_b32 v8, 4, v8
    buffer_load_dword v16, v8, s[8:11], s43 offen sc1
    s_lshl_b32 s35, s36, 12
    s_add_u32 s33, s37, s38
    s_add_u32 m0, s33, 65536
    s_nop 0
    buffer_load_dwordx4 v192, s[8:11], s35 offen offset:0 sc1 lds
    buffer_load_dwordx4 v192, s[8:11], s35 offen offset:1024 sc1 lds
    buffer_load_dwordx4 v197, s[8:11], s35 offen offset:2048 sc1 lds
    buffer_load_dwordx4 v197, s[8:11], s35 offen offset:3072 sc1 lds
    s_add_u32 s33, s37, s39
    s_add_u32 m0, s33, 0
    s_lshl_b32 s27, s36, s44
    buffer_load_dwordx4 v193, s[12:15], s27 offen sc1 lds
    buffer_load_dwordx4 v194, s[12:15], s27 offen offset:1024 sc1 lds
    s_add_u32 m0, s33, 8192
    s_lshl_b32 s27, s36, s48
    buffer_load_dwordx4 v195, s[64:67], s27 offen sc1 lds
    buffer_load_dwordx4 v196, s[64:67], s27 offen offset:1024 sc1 lds
    s_add_u32 s37, s37, 16384
    s_and_b32 s37, s37, 0xffff
    s_add_u32 s36, s36, 7
    s_cmp_eq_u32 s36, s47
    s_cselect_b32 s27, 7, 0
    s_add_u32 s36, s36, s27
    s_cmp_eq_u32 s36, s46
    s_cselect_b32 s27, 55, 0
    s_cselect_b32 s28, 1, 0
    s_sub_u32 s36, s36, s27
    s_add_u32 s46, s46, s28
    s_add_u32 s47, s47, s28
    s_cmp_eq_u32 s36, s47
    s_cselect_b32 s27, 7, 0
    s_add_u32 s36, s36, s27
    s_waitcnt vmcnt(16)
    s_barrier
    s_lshl_b32 s35, s36, 12
    s_add_u32 s33, s37, s38
    s_add_u32 m0, s33, 65536
    s_nop 0
    buffer_load_dwordx4 v192, s[8:11], s35 offen offset:0 sc1 lds
    buffer_load_dwordx4 v192, s[8:11], s35 offen offset:1024 sc1 lds
    buffer_load_dwordx4 v197, s[8:11], s35 offen offset:2048 sc1 lds
    buffer_load_dwordx4 v197, s[8:11], s35 offen offset:3072 sc1 lds
    s_add_u32 s33, s37, s39
    s_add_u32 m0, s33, 0
    s_lshl_b32 s27, s36, s44
    buffer_load_dwordx4 v193, s[12:15], s27 offen sc1 lds
    buffer_load_dwordx4 v194, s[12:15], s27 offen offset:1024 sc1 lds
    s_add_u32 m0, s33, 8192
    s_lshl_b32 s27, s36, s48
    buffer_load_dwordx4 v195, s[64:67], s27 offen sc1 lds
    buffer_load_dwordx4 v196, s[64:67], s27 offen offset:1024 sc1 lds
    s_add_u32 s37, s37, 16384
    s_and_b32 s37, s37, 0xffff
    s_add_u32 s36, s36, 7
    s_cmp_eq_u32 s36, s47
    s_cselect_b32 s27, 7, 0
    s_add_u32 s36, s36, s27
    s_cmp_eq_u32 s36, s46
    s_cselect_b32 s27, 55, 0
    s_cselect_b32 s28, 1, 0
    s_sub_u32 s36, s36, s27
    s_add_u32 s46, s46, s28
    s_add_u32 s47, s47, s28
    s_cmp_eq_u32 s36, s47
    s_cselect_b32 s27, 7, 0
    s_add_u32 s36, s36, s27
    s_waitcnt vmcnt(16)
    s_barrier
    v_cmp_ne_u32 vcc, s78, v16
    s_cbranch_vccz L_hb_51
    v_and_b32 v8, 31, v1
    v_lshlrev_b32 v8, 4, v8
    s_mov_b32 s27, 0
L_poll_52:
    buffer_load_dword v9, v8, s[8:11], s43 offen sc1
    s_add_u32 s27, s27, 1
    s_waitcnt vmcnt(0)
    v_cmp_ne_u32 vcc, s78, v9
    s_cbranch_vccz L_pd_53
    s_sleep 1
    s_cmp_lt_u32 s27, 0x40000
    s_cbranch_scc1 L_poll_52
L_pd_53:
L_hb_51:
    s_lshl_b32 s35, s36, 12
    s_add_u32 s33, s37, s38
    s_add_u32 m0, s33, 65536
    s_nop 0
    buffer_load_dwordx4 v192, s[8:11], s35 offen offset:0 sc1 lds
    buffer_load_dwordx4 v192, s[8:11], s35 offen offset:1024 sc1 lds
    buffer_load_dwordx4 v197, s[8:11], s35 offen offset:2048 sc1 lds
    buffer_load_dwordx4 v197, s[8:11], s35 offen offset:3072 sc1 lds
    s_add_u32 s33, s37, s39
    s_add_u32 m0, s33, 0
    s_lshl_b32 s27, s36, s44
    buffer_load_dwordx4 v193, s[12:15], s27 offen sc1 lds
    buffer_load_dwordx4 v194, s[12:15], s27 offen offset:1024 sc1 lds
    s_add_u32 m0, s33, 8192
    s_lshl_b32 s27, s36, s48
    buffer_load_dwordx4 v195, s[64:67], s27 offen sc1 lds
    buffer_load_dwordx4 v196, s[64:67], s27 offen offset:1024 sc1 lds
    s_add_u32 s37, s37, 16384
    s_and_b32 s37, s37, 0xffff
    s_add_u32 s36, s36, 7
    s_cmp_eq_u32 s36, s47
    s_cselect_b32 s27, 7, 0
    s_add_u32 s36, s36, s27
    s_cmp_eq_u32 s36, s46
    s_cselect_b32 s27, 55, 0
    s_cselect_b32 s28, 1, 0
    s_sub_u32 s36, s36, s27
    s_add_u32 s46, s46, s28
    s_add_u32 s47, s47, s28
    s_cmp_eq_u32 s36, s47
    s_cselect_b32 s27, 7, 0
    s_add_u32 s36, s36, s27
    s_mov_b32 s41, 8
    s_add_u32 s34, s38, 65536
    s_lshl_b32 s35, s36, 12
    s_add_u32 m0, s37, s34
L_ps_54:
    s_waitcnt vmcnt(16)
    s_barrier
    buffer_load_dwordx4 v192, s[8:11], s35 offen offset:0 sc1 lds
    s_lshl_b32 s42, s36, s44
    s_lshl_b32 s45, s36, s48
    s_add_u32 s33, s37, s39
    s_add_u32 s37, s37, 16384
    s_and_b32 s37, s37, 0xffff
    buffer_load_dwordx4 v192, s[8:11], s35 offen offset:1024 sc1 lds
    s_add_u32 s36, s36, 7
    s_cmp_eq_u32 s36, s47
    s_cselect_b32 s27, 7, 0
    s_add_u32 s36, s36, s27
    s_cmp_eq_u32 s36, s46
    s_cselect_b32 s27, 55, 0
    s_cselect_b32 s28, 1, 0
    buffer_load_dwordx4 v197, s[8:11], s35 offen offset:2048 sc1 lds
    s_sub_u32 s36, s36, s27
    s_add_u32 s46, s46, s28
    s_add_u32 s47, s47, s28
    s_cmp_eq_u32 s36, s47
    s_cselect_b32 s27, 7, 0
    s_add_u32 s36, s36, s27
    buffer_load_dwordx4 v197, s[8:11], s35 offen offset:3072 sc1 lds
    s_add_u32 m0, s33, 0
    s_nop 0
    buffer_load_dwordx4 v193, s[12:15], s42 offen sc1 lds
    s_lshl_b32 s35, s36, 12
    s_add_u32 s41, s41, 1
    buffer_load_dwordx4 v194, s[12:15], s42 offen offset:1024 sc1 lds
    s_add_u32 m0, s33, 8192
    s_nop 0
    buffer_load_dwordx4 v195, s[64:67], s45 offen sc1 lds
    buffer_load_dwordx4 v196, s[64:67], s45 offen offset:1024 sc1 lds
    s_add_u32 m0, s37, s34
    s_cmp_lt_u32 s41, 21
    s_cbranch_scc1 L_ps_54
    s_mov_b32 s36, 3
    s_add_u32 s34, s38, 65536
    s_lshl_b32 s35, s36, 12
    s_add_u32 m0, s37, s34
L_ps_55:
    s_waitcnt vmcnt(12)
    s_barrier
    buffer_load_dwordx4 v192, s[8:11], s35 offen offset:0 sc1 lds
    s_lshl_b32 s45, s36, s48
    s_add_u32 s33, s37, s39
    s_add_u32 s37, s37, 16384
    s_and_b32 s37, s37, 0xffff
    buffer_load_dwordx4 v192, s[8:11], s35 offen offset:1024 sc1 lds
    s_add_u32 s36, s36, 7
    buffer_load_dwordx4 v197, s[8:11], s35 offen offset:2048 sc1 lds
    buffer_load_dwordx4 v197, s[8:11], s35 offen offset:3072 sc1 lds
    s_add_u32 m0, s33, 8192
    s_nop 0
    buffer_load_dwordx4 v195, s[64:67], s45 offen sc1 lds
    s_lshl_b32 s35, s36, 12
    s_add_u32 s41, s41, 1
    buffer_load_dwordx4 v196, s[64:67], s45 offen offset:1024 sc1 lds
    s_add_u32 m0, s37, s34
    s_cmp_lt_u32 s41, 29
    s_cbranch_scc1 L_ps_55
    s_waitcnt vmcnt(12)
    s_barrier
    s_cmp_eq_u32 s23, 1
    s_cbranch_scc1 L_f2_plast
    s_and_b32 s27, s21, 7
    s_cmp_eq_u32 s27, 3
    s_cbranch_scc1 L_q1_56
    s_mov_b32 s12, s80
    s_mov_b32 s13, s81
    s_mov_b32 s14, 0x600000
    s_mov_b32 s15, 0x20000
    s_lshl_b32 s42, s21, 7
    s_add_u32 s43, s42, 2048
    s_add_u32 s44, s42, 4096
    v_lshrrev_b32 v4, 3, v1
    v_and_b32 v5, 0x70, v233
    v_xor_b32 v6, 32, v5
    s_mov_b32 s28, 6144
    v_mul_lo_u32 v4, v4, s28
    v_add_u32 v5, v4, v5
    v_add_u32 v6, v4, v6
    s_mul_i32 s29, s26, 98304
    s_add_u32 s27, s29, s42
    v_add_u32 v14, s27, v5
    s_add_u32 s27, s29, s42
    s_add_u32 s27, s27, 49152
    v_add_u32 v15, s27, v6
    s_add_u32 s27, s29, s43
    v_add_u32 v16, s27, v5
    s_add_u32 s27, s29, s43
    s_add_u32 s27, s27, 49152
    v_add_u32 v17, s27, v6
    s_add_u32 s27, s29, s44
    v_add_u32 v18, s27, v5
    s_add_u32 s27, s29, s44
    s_add_u32 s27, s27, 49152
    v_add_u32 v19, s27, v6
    s_mov_b32 s61, 393216
    s_branch L_q2_57
L_q1_56:
    s_add_u32 s12, s4, 0x1c00000
    s_addc_u32 s13, s5, 0
    s_mov_b32 s14, 0x100000
    s_mov_b32 s15, 0x20000
    s_lshr_b32 s27, s21, 3
    s_lshl_b32 s27, s27, 17
    s_add_u32 s27, s27, s39
    s_add_u32 s28, s27, 0x0
    v_add_u32 v14, s28, v2
    s_add_u32 s28, s27, 0x400
    v_add_u32 v15, s28, v2
    s_add_u32 s28, s27, 0x40000
    v_add_u32 v16, s28, v2
    s_add_u32 s28, s27, 0x40400
    v_add_u32 v17, s28, v2
    s_add_u32 s28, s27, 0x80000
    v_add_u32 v18, s28, v2
    s_add_u32 s28, s27, 0x80400
    v_add_u32 v19, s28, v2
    s_mov_b32 s61, 8192
L_q2_57:
    s_mul_i32 s36, s21, s61
    s_mov_b32 s47, s36
    s_lshl_b32 s63, s61, 4
    s_mov_b32 s37, 0
    s_waitcnt vmcnt(6)
    s_barrier
    s_add_u32 s33, s37, s39
    s_add_u32 m0, s33, 65536
    s_nop 0
    buffer_load_dwordx4 v14, s[12:15], s36 offen sc1 lds
    s_add_u32 m0, s33, 66560
    s_nop 0
    buffer_load_dwordx4 v15, s[12:15], s36 offen sc1 lds
    s_add_u32 m0, s33, 73728
    s_nop 0
    buffer_load_dwordx4 v16, s[12:15], s36 offen sc1 lds
    s_add_u32 m0, s33, 74752
    s_nop 0
    buffer_load_dwordx4 v17, s[12:15], s36 offen sc1 lds
    s_add_u32 m0, s33, 81920
    s_nop 0
    buffer_load_dwordx4 v18, s[12:15], s36 offen sc1 lds
    s_add_u32 m0, s33, 82944
    s_nop 0
    buffer_load_dwordx4 v19, s[12:15], s36 offen sc1 lds
    s_mov_b32 s36, 0
    s_cmp_eq_u32 s36, s47
    s_cselect_b32 s27, s61, 0
    s_add_u32 s36, s36, s27
    s_add_u32 s37, s37, 24576
    s_cmp_eq_u32 s37, 73728
    s_cselect_b32 s37, 0, s37
    s_waitcnt vmcnt(6)
    s_barrier
    s_add_u32 s33, s37, s39
    s_add_u32 m0, s33, 65536
    s_nop 0
    buffer_load_dwordx4 v14, s[12:15], s36 offen sc1 lds
    s_add_u32 m0, s33, 66560
    s_nop 0
    buffer_load_dwordx4 v15, s[12:15], s36 offen sc1 lds
    s_add_u32 m0, s33, 73728
    s_nop 0
    buffer_load_dwordx4 v16, s[12:15], s36 offen sc1 lds
    s_add_u32 m0, s33, 74752
    s_nop 0
    buffer_load_dwordx4 v17, s[12:15], s36 offen sc1 lds
    s_add_u32 m0, s33, 81920
    s_nop 0
    buffer_load_dwordx4 v18, s[12:15], s36 offen sc1 lds
    s_add_u32 m0, s33, 82944
    s_nop 0
    buffer_load_dwordx4 v19, s[12:15], s36 offen sc1 lds
    s_add_u32 s36, s36, s61
    s_cmp_eq_u32 s36, s63
    s_cselect_b32 s36, 0, s36
    s_cmp_eq_u32 s36, s47
    s_cselect_b32 s27, s61, 0
    s_add_u32 s36, s36, s27
    s_add_u32 s37, s37, 24576
    s_cmp_eq_u32 s37, 73728
    s_cselect_b32 s37, 0, s37
    s_barrier
    s_branch L_f2_done
L_f2_cons:
    s_setprio 1
    s_xor_b32 s49, s21, 1
    s_lshl_b32 s27, s88, 13
    s_add_u32 s27, s27, 65536
    v_add_u32 v20, s27, v2
    v_lshrrev_b32 v3, 4, v1
    v_bfe_u32 v4, v1, 2, 2
    v_lshlrev_b32 v8, 2, v3
    v_add_u32 v8, v8, v4
    v_lshlrev_b32 v8, 7, v8
    v_and_b32 v5, 3, v1
    v_lshlrev_b32 v5, 3, v5
    v_and_b32 v6, 1, v3
    v_lshrrev_b32 v7, 5, v1
    v_xor_b32 v6, v6, v7
    v_lshlrev_b32 v6, 5, v6
    v_xor_b32 v5, v5, v6
    v_bfe_u32 v6, v1, 3, 1
    v_lshlrev_b32 v6, 6, v6
    v_xor_b32 v5, v5, v6
    s_lshl_b32 s27, s89, 6
    v_xor_b32 v5, s27, v5
    v_add_u32 v8, v8, v5
    v_add_u32 v21, 0, v8
    v_xor_b32 v22, 32, v21
    v_lshrrev_b32 v3, 4, v1
    v_bfe_u32 v4, v1, 2, 2
    v_lshlrev_b32 v8, 3, v3
    v_add_u32 v8, v8, v4
    v_lshlrev_b32 v8, 7, v8
    v_and_b32 v5, 3, v1
    v_lshlrev_b32 v5, 3, v5
    v_and_b32 v6, 1, v3
    v_lshlrev_b32 v6, 5, v6
    v_xor_b32 v5, v5, v6
    v_bfe_u32 v6, v1, 3, 1
    v_lshlrev_b32 v6, 6, v6
    v_xor_b32 v5, v5, v6
    s_lshl_b32 s27, s89, 6
    v_xor_b32 v5, s27, v5
    v_add_u32 v8, v8, v5
    v_add_u32 v26, 8192, v8
    v_xor_b32 v27, 32, v26
    v_lshlrev_b32 v64, 16, v240
    v_and_b32 v65, 0xffff0000, v240
    v_lshlrev_b32 v66, 16, v241
    v_and_b32 v67, 0xffff0000, v241
    v_lshlrev_b32 v68, 16, v242
    v_and_b32 v69, 0xffff0000, v242
    v_lshlrev_b32 v70, 16, v243
    v_and_b32 v71, 0xffff0000, v243
    v_lshlrev_b32 v72, 16, v244
    v_and_b32 v73, 0xffff0000, v244
    v_lshlrev_b32 v74, 16, v245
    v_and_b32 v75, 0xffff0000, v245
    v_lshlrev_b32 v76, 16, v246
    v_and_b32 v77, 0xffff0000, v246
    v_lshlrev_b32 v78, 16, v247
    v_and_b32 v79, 0xffff0000, v247
    v_lshlrev_b32 v80, 16, v248
    v_and_b32 v81, 0xffff0000, v248
    v_lshlrev_b32 v82, 16, v249
    v_and_b32 v83, 0xffff0000, v249
    v_lshlrev_b32 v84, 16, v250
    v_and_b32 v85, 0xffff0000, v250
    v_lshlrev_b32 v86, 16, v251
    v_and_b32 v87, 0xffff0000, v251
    v_lshlrev_b32 v88, 16, v252
    v_and_b32 v89, 0xffff0000, v252
    v_lshlrev_b32 v90, 16, v253
    v_and_b32 v91, 0xffff0000, v253
    v_lshlrev_b32 v92, 16, v254
    v_and_b32 v93, 0xffff0000, v254
    v_lshlrev_b32 v94, 16, v255
    v_and_b32 v95, 0xffff0000, v255
    v_pk_mul_f32 v[64:65], v[64:65], v[216:217] op_sel:[0,1] op_sel_hi:[1,1]
    v_pk_mul_f32 v[66:67], v[66:67], v[216:217] op_sel:[0,1] op_sel_hi:[1,1]
    v_pk_mul_f32 v[68:69], v[68:69], v[216:217] op_sel:[0,1] op_sel_hi:[1,1]
    v_pk_mul_f32 v[70:71], v[70:71], v[216:217] op_sel:[0,1] op_sel_hi:[1,1]
    v_pk_mul_f32 v[72:73], v[72:73], v[218:219] op_sel:[0,1] op_sel_hi:[1,1]
    v_pk_mul_f32 v[74:75], v[74:75], v[218:219] op_sel:[0,1] op_sel_hi:[1,1]
    v_pk_mul_f32 v[76:77], v[76:77], v[218:219] op_sel:[0,1] op_sel_hi:[1,1]
    v_pk_mul_f32 v[78:79], v[78:79], v[218:219] op_sel:[0,1] op_sel_hi:[1,1]
    v_pk_mul_f32 v[80:81], v[80:81], v[220:221] op_sel:[0,1] op_sel_hi:[1,1]
    v_pk_mul_f32 v[82:83], v[82:83], v[220:221] op_sel:[0,1] op_sel_hi:[1,1]
    v_pk_mul_f32 v[84:85], v[84:85], v[220:221] op_sel:[0,1] op_sel_hi:[1,1]
    v_pk_mul_f32 v[86:87], v[86:87], v[220:221] op_sel:[0,1] op_sel_hi:[1,1]
    v_pk_mul_f32 v[88:89], v[88:89], v[222:223] op_sel:[0,1] op_sel_hi:[1,1]
    v_pk_mul_f32 v[90:91], v[90:91], v[222:223] op_sel:[0,1] op_sel_hi:[1,1]
    v_pk_mul_f32 v[92:93], v[92:93], v[222:223] op_sel:[0,1] op_sel_hi:[1,1]
    v_pk_mul_f32 v[94:95], v[94:95], v[222:223] op_sel:[0,1] op_sel_hi:[1,1]
    v_mov_b32 v32, 0
    v_mov_b32 v33, 0
    v_mov_b32 v34, 0
    v_mov_b32 v35, 0
    v_mov_b32 v36, 0
    v_mov_b32 v37, 0
    v_mov_b32 v38, 0
    v_mov_b32 v39, 0
    v_mov_b32 v40, 0
    v_mov_b32 v41, 0
    v_mov_b32 v42, 0
    v_mov_b32 v43, 0
    v_mov_b32 v44, 0
    v_mov_b32 v45, 0
    v_mov_b32 v46, 0
    v_mov_b32 v47, 0
    v_mov_b32 v48, 0
    v_mov_b32 v49, 0
    v_mov_b32 v50, 0
    v_mov_b32 v51, 0
    v_mov_b32 v52, 0
    v_mov_b32 v53, 0
    v_mov_b32 v54, 0
    v_mov_b32 v55, 0
    v_mov_b32 v56, 0
    v_mov_b32 v57, 0
    v_mov_b32 v58, 0
    v_mov_b32 v59, 0
    v_mov_b32 v60, 0
    v_mov_b32 v61, 0
    v_mov_b32 v62, 0
    v_mov_b32 v63, 0
    s_mov_b32 s31, 0
    s_mov_b32 s30, 0
    v_add_u32 v23, s31, v20
    v_add_u32 v24, s31, v21
    v_add_u32 v25, s31, v22
    s_barrier
    ds_read_b128 v[96:99], v23 offset:0
    ds_read_b64_tr_b16 v[128:129], v24 offset:0
    ds_read_b64_tr_b16 v[130:131], v24 offset:2048
    ds_read_b128 v[100:103], v23 offset:1024
    ds_read_b128 v[104:107], v23 offset:4096
    ds_read_b128 v[108:111], v23 offset:5120
    ds_read_b64_tr_b16 v[132:133], v25 offset:0
    ds_read_b64_tr_b16 v[134:135], v25 offset:2048
    ds_read_b64_tr_b16 v[136:137], v24 offset:8192
    ds_read_b64_tr_b16 v[138:139], v24 offset:10240
L_cons_58:
    s_waitcnt lgkmcnt(7)
    v_mfma_f32_16x16x32_bf16 v[32:35], v[128:131], v[96:99], v[32:35]
    ds_read_b64_tr_b16 v[140:141], v25 offset:8192
    s_waitcnt lgkmcnt(7)
    v_mfma_f32_16x16x32_bf16 v[40:43], v[128:131], v[100:103], v[40:43]
    ds_read_b64_tr_b16 v[142:143], v25 offset:10240
    s_waitcnt lgkmcnt(7)
    v_mfma_f32_16x16x32_bf16 v[48:51], v[128:131], v[104:107], v[48:51]
    ds_read_b128 v[112:115], v23 offset:2048
    s_waitcnt lgkmcnt(7)
    v_mfma_f32_16x16x32_bf16 v[56:59], v[128:131], v[108:111], v[56:59]
    ds_read_b64_tr_b16 v[128:129], v24 offset:4096
    s_waitcnt lgkmcnt(6)
    v_mfma_f32_16x16x32_bf16 v[36:39], v[132:135], v[96:99], v[36:39]
    ds_read_b64_tr_b16 v[130:131], v24 offset:6144
    v_mfma_f32_16x16x32_bf16 v[44:47], v[132:135], v[100:103], v[44:47]
    ds_read_b128 v[116:119], v23 offset:3072
    v_mfma_f32_16x16x32_bf16 v[52:55], v[132:135], v[104:107], v[52:55]
    ds_read_b128 v[120:123], v23 offset:6144
    v_mfma_f32_16x16x32_bf16 v[60:63], v[132:135], v[108:111], v[60:63]
    ds_read_b128 v[124:127], v23 offset:7168
    s_waitcnt lgkmcnt(7)
    v_mfma_f32_16x16x32_bf16 v[64:67], v[136:139], v[96:99], v[64:67]
    ds_read_b64_tr_b16 v[132:133], v25 offset:4096
    v_mfma_f32_16x16x32_bf16 v[72:75], v[136:139], v[100:103], v[72:75]
    ds_read_b64_tr_b16 v[134:135], v25 offset:6144
    v_mfma_f32_16x16x32_bf16 v[80:83], v[136:139], v[104:107], v[80:83]
    s_add_u32 s31, s31, 16384
    v_mfma_f32_16x16x32_bf16 v[88:91], v[136:139], v[108:111], v[88:91]
    ds_read_b64_tr_b16 v[136:137], v24 offset:12288
    s_waitcnt lgkmcnt(6)
    v_mfma_f32_16x16x32_bf16 v[68:71], v[140:143], v[96:99], v[68:71]
    ds_read_b64_tr_b16 v[138:139], v24 offset:14336
    v_mfma_f32_16x16x32_bf16 v[76:79], v[140:143], v[100:103], v[76:79]
    s_cmp_eq_u32 s31, 65536
    v_mfma_f32_16x16x32_bf16 v[84:87], v[140:143], v[104:107], v[84:87]
    s_cselect_b32 s31, 0, s31
    v_mfma_f32_16x16x32_bf16 v[92:95], v[140:143], v[108:111], v[92:95]
    ds_read_b64_tr_b16 v[140:141], v25 offset:12288
    v_mfma_f32_16x16x32_bf16 v[32:35], v[128:131], v[112:115], v[32:35]
    ds_read_b64_tr_b16 v[142:143], v25 offset:14336
    s_waitcnt lgkmcnt(4)
    v_mfma_f32_16x16x32_bf16 v[40:43], v[128:131], v[116:119], v[40:43]
    s_add_u32 s30, s30, 1
    v_mfma_f32_16x16x32_bf16 v[48:51], v[128:131], v[120:123], v[48:51]
    s_cmp_lt_u32 s30, 1
    v_mfma_f32_16x16x32_bf16 v[56:59], v[128:131], v[124:127], v[56:59]
    v_add_u32 v23, s31, v20
    v_mfma_f32_16x16x32_bf16 v[36:39], v[132:135], v[112:115], v[36:39]
    v_add_u32 v24, s31, v21
    v_mfma_f32_16x16x32_bf16 v[44:47], v[132:135], v[116:119], v[44:47]
    v_add_u32 v25, s31, v22
    v_mfma_f32_16x16x32_bf16 v[52:55], v[132:135], v[120:123], v[52:55]
    s_waitcnt lgkmcnt(0)
    s_barrier
    v_mfma_f32_16x16x32_bf16 v[60:63], v[132:135], v[124:127], v[60:63]
    ds_read_b128 v[96:99], v23 offset:0
    ds_read_b64_tr_b16 v[128:129], v24 offset:0
    v_mfma_f32_16x16x32_bf16 v[64:67], v[136:139], v[112:115], v[64:67]
    ds_read_b64_tr_b16 v[130:131], v24 offset:2048
    v_mfma_f32_16x16x32_bf16 v[72:75], v[136:139], v[116:119], v[72:75]
    ds_read_b128 v[100:103], v23 offset:1024
    v_mfma_f32_16x16x32_bf16 v[80:83], v[136:139], v[120:123], v[80:83]
    ds_read_b128 v[104:107], v23 offset:4096
    v_mfma_f32_16x16x32_bf16 v[88:91], v[136:139], v[124:127], v[88:91]
    ds_read_b128 v[108:111], v23 offset:5120
    v_mfma_f32_16x16x32_bf16 v[68:71], v[140:143], v[112:115], v[68:71]
    ds_read_b64_tr_b16 v[132:133], v25 offset:0
    v_mfma_f32_16x16x32_bf16 v[76:79], v[140:143], v[116:119], v[76:79]
    ds_read_b64_tr_b16 v[134:135], v25 offset:2048
    v_mfma_f32_16x16x32_bf16 v[84:87], v[140:143], v[120:123], v[84:87]
    ds_read_b64_tr_b16 v[136:137], v24 offset:8192
    v_mfma_f32_16x16x32_bf16 v[92:95], v[140:143], v[124:127], v[92:95]
    ds_read_b64_tr_b16 v[138:139], v24 offset:10240
    s_cbranch_scc1 L_cons_58
    s_lshl_b32 s27, s6, 9
    s_lshl_b32 s28, s7, 4
    s_add_u32 s27, s27, s28
    s_add_u32 s27, s27, 0x19c0000
    v_mov_b32 v4, 0
    v_mov_b32 v5, s78
    s_waitcnt vmcnt(0)
    s_mov_b64 exec, 1
    buffer_store_dword v5, v4, s[8:11], s27 offen sc1
    s_mov_b64 exec, -1
L_cons_59:
    s_waitcnt lgkmcnt(7)
    v_mfma_f32_16x16x32_bf16 v[32:35], v[128:131], v[96:99], v[32:35]
    ds_read_b64_tr_b16 v[140:141], v25 offset:8192
    s_waitcnt lgkmcnt(7)
    v_mfma_f32_16x16x32_bf16 v[40:43], v[128:131], v[100:103], v[40:43]
    ds_read_b64_tr_b16 v[142:143], v25 offset:10240
    s_waitcnt lgkmcnt(7)
    v_mfma_f32_16x16x32_bf16 v[48:51], v[128:131], v[104:107], v[48:51]
    ds_read_b128 v[112:115], v23 offset:2048
    s_waitcnt lgkmcnt(7)
    v_mfma_f32_16x16x32_bf16 v[56:59], v[128:131], v[108:111], v[56:59]
    ds_read_b64_tr_b16 v[128:129], v24 offset:4096
    s_waitcnt lgkmcnt(6)
    v_mfma_f32_16x16x32_bf16 v[36:39], v[132:135], v[96:99], v[36:39]
    ds_read_b64_tr_b16 v[130:131], v24 offset:6144
    v_mfma_f32_16x16x32_bf16 v[44:47], v[132:135], v[100:103], v[44:47]
    ds_read_b128 v[116:119], v23 offset:3072
    v_mfma_f32_16x16x32_bf16 v[52:55], v[132:135], v[104:107], v[52:55]
    ds_read_b128 v[120:123], v23 offset:6144
    v_mfma_f32_16x16x32_bf16 v[60:63], v[132:135], v[108:111], v[60:63]
    ds_read_b128 v[124:127], v23 offset:7168
    s_waitcnt lgkmcnt(7)
    v_mfma_f32_16x16x32_bf16 v[64:67], v[136:139], v[96:99], v[64:67]
    ds_read_b64_tr_b16 v[132:133], v25 offset:4096
    v_mfma_f32_16x16x32_bf16 v[72:75], v[136:139], v[100:103], v[72:75]
    ds_read_b64_tr_b16 v[134:135], v25 offset:6144
    v_mfma_f32_16x16x32_bf16 v[80:83], v[136:139], v[104:107], v[80:83]
    s_add_u32 s31, s31, 16384
    v_mfma_f32_16x16x32_bf16 v[88:91], v[136:139], v[108:111], v[88:91]
    ds_read_b64_tr_b16 v[136:137], v24 offset:12288
    s_waitcnt lgkmcnt(6)
    v_mfma_f32_16x16x32_bf16 v[68:71], v[140:143], v[96:99], v[68:71]
    ds_read_b64_tr_b16 v[138:139], v24 offset:14336
    v_mfma_f32_16x16x32_bf16 v[76:79], v[140:143], v[100:103], v[76:79]
    s_cmp_eq_u32 s31, 65536
    v_mfma_f32_16x16x32_bf16 v[84:87], v[140:143], v[104:107], v[84:87]
    s_cselect_b32 s31, 0, s31
    v_mfma_f32_16x16x32_bf16 v[92:95], v[140:143], v[108:111], v[92:95]
    ds_read_b64_tr_b16 v[140:141], v25 offset:12288
    v_mfma_f32_16x16x32_bf16 v[32:35], v[128:131], v[112:115], v[32:35]
    ds_read_b64_tr_b16 v[142:143], v25 offset:14336
    s_waitcnt lgkmcnt(4)
    v_mfma_f32_16x16x32_bf16 v[40:43], v[128:131], v[116:119], v[40:43]
    s_add_u32 s30, s30, 1
    v_mfma_f32_16x16x32_bf16 v[48:51], v[128:131], v[120:123], v[48:51]
    s_cmp_lt_u32 s30, 24
    v_mfma_f32_16x16x32_bf16 v[56:59], v[128:131], v[124:127], v[56:59]
    v_add_u32 v23, s31, v20
    v_mfma_f32_16x16x32_bf16 v[36:39], v[132:135], v[112:115], v[36:39]
    v_add_u32 v24, s31, v21
    v_mfma_f32_16x16x32_bf16 v[44:47], v[132:135], v[116:119], v[44:47]
    v_add_u32 v25, s31, v22
    v_mfma_f32_16x16x32_bf16 v[52:55], v[132:135], v[120:123], v[52:55]
    s_waitcnt lgkmcnt(0)
    s_barrier
    v_mfma_f32_16x16x32_bf16 v[60:63], v[132:135], v[124:127], v[60:63]
    ds_read_b128 v[96:99], v23 offset:0
    ds_read_b64_tr_b16 v[128:129], v24 offset:0
    v_mfma_f32_16x16x32_bf16 v[64:67], v[136:139], v[112:115], v[64:67]
    ds_read_b64_tr_b16 v[130:131], v24 offset:2048
    v_mfma_f32_16x16x32_bf16 v[72:75], v[136:139], v[116:119], v[72:75]
    ds_read_b128 v[100:103], v23 offset:1024
    v_mfma_f32_16x16x32_bf16 v[80:83], v[136:139], v[120:123], v[80:83]
    ds_read_b128 v[104:107], v23 offset:4096
    v_mfma_f32_16x16x32_bf16 v[88:91], v[136:139], v[124:127], v[88:91]
    ds_read_b128 v[108:111], v23 offset:5120
    v_mfma_f32_16x16x32_bf16 v[68:71], v[140:143], v[112:115], v[68:71]
    ds_read_b64_tr_b16 v[132:133], v25 offset:0
    v_mfma_f32_16x16x32_bf16 v[76:79], v[140:143], v[116:119], v[76:79]
    ds_read_b64_tr_b16 v[134:135], v25 offset:2048
    v_mfma_f32_16x16x32_bf16 v[84:87], v[140:143], v[120:123], v[84:87]
    ds_read_b64_tr_b16 v[136:137], v24 offset:8192
    v_mfma_f32_16x16x32_bf16 v[92:95], v[140:143], v[124:127], v[92:95]
    ds_read_b64_tr_b16 v[138:139], v24 offset:10240
    s_cbranch_scc1 L_cons_59
    s_waitcnt lgkmcnt(0)
    s_mov_b32 s30, 0
    v_add_u32 v23, s31, v20
    v_add_u32 v24, s31, v26
    v_add_u32 v25, s31, v27
    ds_read_b128 v[96:99], v23 offset:0
    ds_read_b64_tr_b16 v[128:129], v24 offset:0
    ds_read_b64_tr_b16 v[130:131], v25 offset:512
    ds_read_b128 v[100:103], v23 offset:1024
    ds_read_b128 v[104:107], v23 offset:4096
    ds_read_b128 v[108:111], v23 offset:5120
    ds_read_b64_tr_b16 v[132:133], v25 offset:0
    ds_read_b64_tr_b16 v[134:135], v24 offset:512
    ds_read_b128 v[112:115], v23 offset:2048
    ds_read_b64_tr_b16 v[136:137], v24 offset:4096
    ds_read_b64_tr_b16 v[138:139], v25 offset:4608
    ds_read_b128 v[116:119], v23 offset:3072
    ds_read_b128 v[120:123], v23 offset:6144
    ds_read_b128 v[124:127], v23 offset:7168
    ds_read_b64_tr_b16 v[140:141], v25 offset:4096
    s_lshl_b32 s27, s3, 4
    s_add_u32 s32, s27, s49
    s_add_u32 s29, s27, s21
    s_mul_i32 s32, s32, 6144
    s_add_u32 s32, s32, 0x1000000
    s_add_u32 s33, s32, 4096
    s_mul_i32 s29, s29, 6144
    s_add_u32 s29, s29, 0x1000000
    s_add_u32 s34, s29, 4096
    v_mov_b32 v163, s78
    v_mov_b32 v167, s78
    v_mov_b32 v171, s78
    v_mov_b32 v175, s78
    v_mov_b32 v179, s78
    v_mov_b32 v183, s78
    v_mov_b32 v181, 0
    v_mov_b32 v182, 0
    v_cvt_pk_bf16_f32 v160, v32, v33
    v_cvt_pk_bf16_f32 v161, v34, v35
    v_cvt_pk_bf16_f32 v162, v36, v37
    v_cvt_pk_bf16_f32 v164, v38, v39
    v_cvt_pk_bf16_f32 v165, v40, v41
    v_cvt_pk_bf16_f32 v166, v42, v43
    v_cvt_pk_bf16_f32 v168, v44, v45
    v_cvt_pk_bf16_f32 v169, v46, v47
    v_cvt_pk_bf16_f32 v170, v48, v49
    v_cvt_pk_bf16_f32 v172, v50, v51
    v_cvt_pk_bf16_f32 v173, v52, v53
    v_cvt_pk_bf16_f32 v174, v54, v55
    v_cvt_pk_bf16_f32 v176, v56, v57
    v_cvt_pk_bf16_f32 v177, v58, v59
    v_cvt_pk_bf16_f32 v178, v60, v61
    v_cvt_pk_bf16_f32 v180, v62, v63
    buffer_store_dwordx4 v[160:163], v2, s[8:11], s32 offen offset:0 sc1
    buffer_store_dwordx4 v[164:167], v2, s[8:11], s32 offen offset:1024 sc1
    buffer_store_dwordx4 v[168:171], v2, s[8:11], s32 offen offset:2048 sc1
    buffer_store_dwordx4 v[172:175], v2, s[8:11], s32 offen offset:3072 sc1
    buffer_store_dwordx4 v[176:179], v2, s[8:11], s33 offen offset:0 sc1
    buffer_store_dwordx4 v[180:183], v2, s[8:11], s33 offen offset:1024 sc1
L_cons_60:
    s_waitcnt lgkmcnt(7)
    v_mfma_f32_16x16x32_bf16 v[64:67], v[128:131], v[96:99], v[64:67]
    ds_read_b64_tr_b16 v[142:143], v24 offset:4608
    v_mfma_f32_16x16x32_bf16 v[72:75], v[128:131], v[100:103], v[72:75]
    s_add_u32 s31, s31, 16384
    v_mfma_f32_16x16x32_bf16 v[80:83], v[128:131], v[104:107], v[80:83]
    s_cmp_eq_u32 s31, 65536
    v_mfma_f32_16x16x32_bf16 v[88:91], v[128:131], v[108:111], v[88:91]
    s_cselect_b32 s31, 0, s31
    s_add_u32 s30, s30, 1
    v_add_u32 v23, s31, v20
    v_add_u32 v25, s31, v27
    v_mfma_f32_16x16x32_bf16 v[68:71], v[132:135], v[96:99], v[68:71]
    s_cmp_lt_u32 s30, 5
    v_add_u32 v24, s31, v26
    s_waitcnt lgkmcnt(0)
    s_barrier
    v_mfma_f32_16x16x32_bf16 v[76:79], v[132:135], v[100:103], v[76:79]
    ds_read_b128 v[96:99], v23 offset:0
    ds_read_b64_tr_b16 v[128:129], v24 offset:0
    ds_read_b64_tr_b16 v[130:131], v25 offset:512
    ds_read_b128 v[100:103], v23 offset:1024
    v_mfma_f32_16x16x32_bf16 v[84:87], v[132:135], v[104:107], v[84:87]
    ds_read_b128 v[104:107], v23 offset:4096
    v_mfma_f32_16x16x32_bf16 v[92:95], v[132:135], v[108:111], v[92:95]
    ds_read_b128 v[108:111], v23 offset:5120
    ds_read_b64_tr_b16 v[132:133], v25 offset:0
    v_mfma_f32_16x16x32_bf16 v[64:67], v[136:139], v[112:115], v[64:67]
    ds_read_b64_tr_b16 v[134:135], v24 offset:512
    v_mfma_f32_16x16x32_bf16 v[72:75], v[136:139], v[116:119], v[72:75]
    v_mfma_f32_16x16x32_bf16 v[80:83], v[136:139], v[120:123], v[80:83]
    v_mfma_f32_16x16x32_bf16 v[88:91], v[136:139], v[124:127], v[88:91]
    v_mfma_f32_16x16x32_bf16 v[68:71], v[140:143], v[112:115], v[68:71]
    ds_read_b128 v[112:115], v23 offset:2048
    ds_read_b64_tr_b16 v[136:137], v24 offset:4096
    v_mfma_f32_16x16x32_bf16 v[76:79], v[140:143], v[116:119], v[76:79]
    ds_read_b64_tr_b16 v[138:139], v25 offset:4608
    ds_read_b128 v[116:119], v23 offset:3072
    v_mfma_f32_16x16x32_bf16 v[84:87], v[140:143], v[120:123], v[84:87]
    ds_read_b128 v[120:123], v23 offset:6144
    v_mfma_f32_16x16x32_bf16 v[92:95], v[140:143], v[124:127], v[92:95]
    ds_read_b128 v[124:127], v23 offset:7168
    ds_read_b64_tr_b16 v[140:141], v25 offset:4096
    s_cbranch_scc1 L_cons_60
    buffer_load_dwordx4 v[184:187], v2, s[8:11], s29 offen offset:0 sc1
    buffer_load_dwordx4 v[188:191], v2, s[8:11], s29 offen offset:1024 sc1
    buffer_load_dwordx4 v[192:195], v2, s[8:11], s29 offen offset:2048 sc1
    buffer_load_dwordx4 v[196:199], v2, s[8:11], s29 offen offset:3072 sc1
    buffer_load_dwordx4 v[200:203], v2, s[8:11], s34 offen offset:0 sc1
    buffer_load_dwordx4 v[204:207], v2, s[8:11], s34 offen offset:1024 sc1
L_cons_61:
    s_waitcnt lgkmcnt(7)
    v_mfma_f32_16x16x32_bf16 v[64:67], v[128:131], v[96:99], v[64:67]
    ds_read_b64_tr_b16 v[142:143], v24 offset:4608
    v_mfma_f32_16x16x32_bf16 v[72:75], v[128:131], v[100:103], v[72:75]
    s_add_u32 s31, s31, 16384
    v_mfma_f32_16x16x32_bf16 v[80:83], v[128:131], v[104:107], v[80:83]
    s_cmp_eq_u32 s31, 65536
    v_mfma_f32_16x16x32_bf16 v[88:91], v[128:131], v[108:111], v[88:91]
    s_cselect_b32 s31, 0, s31
    s_add_u32 s30, s30, 1
    v_add_u32 v23, s31, v20
    v_add_u32 v25, s31, v27
    v_mfma_f32_16x16x32_bf16 v[68:71], v[132:135], v[96:99], v[68:71]
    s_cmp_lt_u32 s30, 8
    v_add_u32 v24, s31, v26
    s_waitcnt lgkmcnt(0)
    s_barrier
    v_mfma_f32_16x16x32_bf16 v[76:79], v[132:135], v[100:103], v[76:79]
    ds_read_b128 v[96:99], v23 offset:0
    ds_read_b64_tr_b16 v[128:129], v24 offset:0
    ds_read_b64_tr_b16 v[130:131], v25 offset:512
    ds_read_b128 v[100:103], v23 offset:1024
    v_mfma_f32_16x16x32_bf16 v[84:87], v[132:135], v[104:107], v[84:87]
    ds_read_b128 v[104:107], v23 offset:4096
    v_mfma_f32_16x16x32_bf16 v[92:95], v[132:135], v[108:111], v[92:95]
    ds_read_b128 v[108:111], v23 offset:5120
    ds_read_b64_tr_b16 v[132:133], v25 offset:0
    v_mfma_f32_16x16x32_bf16 v[64:67], v[136:139], v[112:115], v[64:67]
    ds_read_b64_tr_b16 v[134:135], v24 offset:512
    v_mfma_f32_16x16x32_bf16 v[72:75], v[136:139], v[116:119], v[72:75]
    v_mfma_f32_16x16x32_bf16 v[80:83], v[136:139], v[120:123], v[80:83]
    v_mfma_f32_16x16x32_bf16 v[88:91], v[136:139], v[124:127], v[88:91]
    v_mfma_f32_16x16x32_bf16 v[68:71], v[140:143], v[112:115], v[68:71]
    ds_read_b128 v[112:115], v23 offset:2048
    ds_read_b64_tr_b16 v[136:137], v24 offset:4096
    v_mfma_f32_16x16x32_bf16 v[76:79], v[140:143], v[116:119], v[76:79]
    ds_read_b64_tr_b16 v[138:139], v25 offset:4608
    ds_read_b128 v[116:119], v23 offset:3072
    v_mfma_f32_16x16x32_bf16 v[84:87], v[140:143], v[120:123], v[84:87]
    ds_read_b128 v[120:123], v23 offset:6144
    v_mfma_f32_16x16x32_bf16 v[92:95], v[140:143], v[124:127], v[92:95]
    ds_read_b128 v[124:127], v23 offset:7168
    ds_read_b64_tr_b16 v[140:141], v25 offset:4096
    s_cbranch_scc1 L_cons_61
    s_waitcnt lgkmcnt(0)
    v_mov_b32 v8, 0x3f80
    v_mov_b32 v9, 0x3f800000
    s_mov_b32 s35, 0
L_ex_chk:
    s_waitcnt vmcnt(0)
    v_xor_b32 v6, s78, v187
    v_xor_b32 v5, s78, v191
    v_or_b32 v6, v6, v5
    v_xor_b32 v5, s78, v195
    v_or_b32 v6, v6, v5
    v_xor_b32 v5, s78, v199
    v_or_b32 v6, v6, v5
    v_xor_b32 v5, s78, v203
    v_or_b32 v6, v6, v5
    v_xor_b32 v5, s78, v207
    v_or_b32 v6, v6, v5
    v_cmp_ne_u32 vcc, 0, v6
    s_cbranch_vccz L_ex_ok
    buffer_load_dwordx4 v[184:187], v2, s[8:11], s29 offen offset:0 sc1
    buffer_load_dwordx4 v[188:191], v2, s[8:11], s29 offen offset:1024 sc1
    buffer_load_dwordx4 v[192:195], v2, s[8:11], s29 offen offset:2048 sc1
    buffer_load_dwordx4 v[196:199], v2, s[8:11], s29 offen offset:3072 sc1
    buffer_load_dwordx4 v[200:203], v2, s[8:11], s34 offen offset:0 sc1
    buffer_load_dwordx4 v[204:207], v2, s[8:11], s34 offen offset:1024 sc1
    s_add_u32 s35, s35, 1
    s_cmp_lt_u32 s35, 0x40000
    s_cbranch_scc1 L_ex_chk
    s_waitcnt vmcnt(0)
L_ex_ok:
    v_dot2_f32_bf16 v64, v184, v8, v64
    v_dot2_f32_bf16 v65, v184, v9, v65
    v_dot2_f32_bf16 v66, v185, v8, v66
    v_dot2_f32_bf16 v67, v185, v9, v67
    v_dot2_f32_bf16 v68, v186, v8, v68
    v_dot2_f32_bf16 v69, v186, v9, v69
    v_dot2_f32_bf16 v70, v188, v8, v70
    v_dot2_f32_bf16 v71, v188, v9, v71
    v_dot2_f32_bf16 v72, v189, v8, v72
    v_dot2_f32_bf16 v73, v189, v9, v73
    v_dot2_f32_bf16 v74, v190, v8, v74
    v_dot2_f32_bf16 v75, v190, v9, v75
    v_dot2_f32_bf16 v76, v192, v8, v76
    v_dot2_f32_bf16 v77, v192, v9, v77
    v_dot2_f32_bf16 v78, v193, v8, v78
    v_dot2_f32_bf16 v79, v193, v9, v79
    v_dot2_f32_bf16 v80, v194, v8, v80
    v_dot2_f32_bf16 v81, v194, v9, v81
    v_dot2_f32_bf16 v82, v196, v8, v82
    v_dot2_f32_bf16 v83, v196, v9, v83
    v_dot2_f32_bf16 v84, v197, v8, v84
    v_dot2_f32_bf16 v85, v197, v9, v85
    v_dot2_f32_bf16 v86, v198, v8, v86
    v_dot2_f32_bf16 v87, v198, v9, v87
    v_dot2_f32_bf16 v88, v200, v8, v88
    v_dot2_f32_bf16 v89, v200, v9, v89
    v_dot2_f32_bf16 v90, v201, v8, v90
    v_dot2_f32_bf16 v91, v201, v9, v91
    v_dot2_f32_bf16 v92, v202, v8, v92
    v_dot2_f32_bf16 v93, v202, v9, v93
    v_dot2_f32_bf16 v94, v204, v8, v94
    v_dot2_f32_bf16 v95, v204, v9, v95
    s_nop 2
    v_pk_mul_f32 v[64:65], v[64:65], v[216:217] op_sel_hi:[1,0]
    v_pk_mul_f32 v[66:67], v[66:67], v[216:217] op_sel_hi:[1,0]
    v_pk_mul_f32 v[68:69], v[68:69], v[216:217] op_sel_hi:[1,0]
    v_pk_mul_f32 v[70:71], v[70:71], v[216:217] op_sel_hi:[1,0]
    v_pk_mul_f32 v[72:73], v[72:73], v[218:219] op_sel_hi:[1,0]
    v_pk_mul_f32 v[74:75], v[74:75], v[218:219] op_sel_hi:[1,0]
    v_pk_mul_f32 v[76:77], v[76:77], v[218:219] op_sel_hi:[1,0]
    v_pk_mul_f32 v[78:79], v[78:79], v[218:219] op_sel_hi:[1,0]
    v_pk_mul_f32 v[80:81], v[80:81], v[220:221] op_sel_hi:[1,0]
    v_pk_mul_f32 v[82:83], v[82:83], v[220:221] op_sel_hi:[1,0]
    v_pk_mul_f32 v[84:85], v[84:85], v[220:221] op_sel_hi:[1,0]
    v_pk_mul_f32 v[86:87], v[86:87], v[220:221] op_sel_hi:[1,0]
    v_pk_mul_f32 v[88:89], v[88:89], v[222:223] op_sel_hi:[1,0]
    v_pk_mul_f32 v[90:91], v[90:91], v[222:223] op_sel_hi:[1,0]
    v_pk_mul_f32 v[92:93], v[92:93], v[222:223] op_sel_hi:[1,0]
    v_pk_mul_f32 v[94:95], v[94:95], v[222:223] op_sel_hi:[1,0]
    s_cmp_eq_u32 s23, 1
    s_cbranch_scc1 L_final
    v_cvt_pk_bf16_f32 v240, v64, v65
    v_cvt_pk_bf16_f32 v241, v66, v67
    v_cvt_pk_bf16_f32 v242, v68, v69
    v_cvt_pk_bf16_f32 v243, v70, v71
    v_cvt_pk_bf16_f32 v244, v72, v73
    v_cvt_pk_bf16_f32 v245, v74, v75
    v_cvt_pk_bf16_f32 v246, v76, v77
    v_cvt_pk_bf16_f32 v247, v78, v79
    v_cvt_pk_bf16_f32 v248, v80, v81
    v_cvt_pk_bf16_f32 v249, v82, v83
    v_cvt_pk_bf16_f32 v250, v84, v85
    v_cvt_pk_bf16_f32 v251, v86, v87
    v_cvt_pk_bf16_f32 v252, v88, v89
    v_cvt_pk_bf16_f32 v253, v90, v91
    v_cvt_pk_bf16_f32 v254, v92, v93
    v_cvt_pk_bf16_f32 v255, v94, v95
    s_lshl_b32 s27, s6, 17
    s_lshl_b32 s28, s7, 11
    s_add_u32 s27, s27, s28
    s_add_u32 s29, s27, 65536
    s_add_u32 s36, s78, 16
    buffer_store_dwordx4 v[240:243], v2, s[16:19], s27 offen offset:0 sc1
    buffer_store_dwordx4 v[244:247], v2, s[16:19], s27 offen offset:1024 sc1
    buffer_store_dwordx4 v[248:251], v2, s[16:19], s29 offen offset:0 sc1
    buffer_store_dwordx4 v[252:255], v2, s[16:19], s29 offen offset:1024 sc1
    s_lshl_b32 s27, s88, 13
    s_lshl_b32 s28, s89, 11
    s_add_u32 s27, s27, s28
    v_add_u32 v10, s27, v2
    ds_write_b128 v10, v[240:243] offset:0
    ds_write_b128 v10, v[244:247] offset:1024
    ds_write_b128 v10, v[248:251] offset:4096
    ds_write_b128 v10, v[252:255] offset:5120
    s_lshl_b32 s29, s6, 9
    s_lshl_b32 s28, s7, 4
    s_add_u32 s29, s29, s28
    s_add_u32 s29, s29, 0x1a00000
    v_mov_b32 v3, 0x3f803f80
    v_mov_b32 v12, 0
    v_mov_b32 v13, 0
    v_mov_b32 v14, 0
    v_mov_b32 v15, 0
    v_mov_b32 v16, 0
    v_mov_b32 v17, 0
    v_mov_b32 v18, 0
    v_mov_b32 v19, 0
    v_dot2_f32_bf16 v12, v240, v3, v12
    v_dot2_f32_bf16 v13, v240, v240, v13
    v_dot2_f32_bf16 v14, v244, v3, v14
    v_dot2_f32_bf16 v15, v244, v244, v15
    v_dot2_f32_bf16 v16, v248, v3, v16
    v_dot2_f32_bf16 v17, v248, v248, v17
    v_dot2_f32_bf16 v18, v252, v3, v18
    v_dot2_f32_bf16 v19, v252, v252, v19
    v_dot2_f32_bf16 v12, v241, v3, v12
    v_dot2_f32_bf16 v13, v241, v241, v13
    v_dot2_f32_bf16 v14, v245, v3, v14
    v_dot2_f32_bf16 v15, v245, v245, v15
    v_dot2_f32_bf16 v16, v249, v3, v16
    v_dot2_f32_bf16 v17, v249, v249, v17
    v_dot2_f32_bf16 v18, v253, v3, v18
    v_dot2_f32_bf16 v19, v253, v253, v19
    v_dot2_f32_bf16 v12, v242, v3, v12
    v_dot2_f32_bf16 v13, v242, v242, v13
    v_dot2_f32_bf16 v14, v246, v3, v14
    v_dot2_f32_bf16 v15, v246, v246, v15
    v_dot2_f32_bf16 v16, v250, v3, v16
    v_dot2_f32_bf16 v17, v250, v250, v17
    v_dot2_f32_bf16 v18, v254, v3, v18
    v_dot2_f32_bf16 v19, v254, v254, v19
    v_dot2_f32_bf16 v12, v243, v3, v12
    v_dot2_f32_bf16 v13, v243, v243, v13
    v_dot2_f32_bf16 v14, v247, v3, v14
    v_dot2_f32_bf16 v15, v247, v247, v15
    v_dot2_f32_bf16 v16, v251, v3, v16
    v_dot2_f32_bf16 v17, v251, v251, v17
    v_dot2_f32_bf16 v18, v255, v3, v18
    v_dot2_f32_bf16 v19, v255, v255, v19
    s_lshl_b32 s27, s6, 14
    s_lshl_b32 s28, s21, 10
    s_add_u32 s27, s27, s28
    s_lshl_b32 s28, s89, 3
    s_add_u32 s27, s27, s28
    s_add_u32 s27, s27, 0x1600000
    v_permlane32_swap_b32 v12, v16
    v_permlane32_swap_b32 v13, v17
    v_permlane32_swap_b32 v14, v18
    v_permlane32_swap_b32 v15, v19
    v_add_f32 v12, v12, v16
    v_add_f32 v13, v13, v17
    v_add_f32 v14, v14, v18
    v_add_f32 v15, v15, v19
    s_nop 1
    v_permlane16_swap_b32 v12, v14
    v_permlane16_swap_b32 v13, v15
    v_add_f32 v16, v12, v14
    v_add_f32 v17, v13, v15
    buffer_store_dwordx2 v[16:17], v2, s[8:11], s27 offen sc1
    v_mov_b32 v4, 0
    v_mov_b32 v5, s36
    s_waitcnt vmcnt(0)
    s_mov_b64 exec, 1
    buffer_store_dword v5, v4, s[8:11], s29 offen sc1
    s_mov_b64 exec, -1
    s_waitcnt lgkmcnt(0)
    s_setprio 0
L_f2_done:
    s_cmp_eq_u32 s23, 1
    s_cbranch_scc1 L_end
    s_mov_b32 s23, 1
    s_add_u32 s78, s78, 16
    s_branch L_layer
L_final:
    v_and_b32 v4, 31, v1
    v_lshlrev_b32 v4, 11, v4
    v_lshrrev_b32 v5, 5, v1
    v_lshlrev_b32 v5, 4, v5
    v_add_u32 v4, v4, v5
    s_lshl_b32 s27, s6, 17
    s_lshl_b32 s28, s7, 6
    s_add_u32 s27, s27, s28
    s_add_u32 s28, s27, 65536
    v_cvt_pk_bf16_f32 v240, v64, v65
    v_cvt_pk_bf16_f32 v241, v66, v67
    v_cvt_pk_bf16_f32 v242, v72, v73
    v_cvt_pk_bf16_f32 v243, v74, v75
    v_cvt_pk_bf16_f32 v244, v68, v69
    v_cvt_pk_bf16_f32 v245, v70, v71
    v_cvt_pk_bf16_f32 v246, v76, v77
    v_cvt_pk_bf16_f32 v247, v78, v79
    v_cvt_pk_bf16_f32 v248, v80, v81
    v_cvt_pk_bf16_f32 v249, v82, v83
    v_cvt_pk_bf16_f32 v250, v88, v89
    v_cvt_pk_bf16_f32 v251, v90, v91
    v_cvt_pk_bf16_f32 v252, v84, v85
    v_cvt_pk_bf16_f32 v253, v86, v87
    v_cvt_pk_bf16_f32 v254, v92, v93
    v_cvt_pk_bf16_f32 v255, v94, v95
    s_nop 0
    v_permlane16_swap_b32 v240, v242
    v_permlane16_swap_b32 v241, v243
    buffer_store_dwordx4 v[240:243], v4, s[16:19], s27 offen offset:0
    v_permlane16_swap_b32 v244, v246
    v_permlane16_swap_b32 v245, v247
    buffer_store_dwordx4 v[244:247], v4, s[16:19], s27 offen offset:32
    v_permlane16_swap_b32 v248, v250
    v_permlane16_swap_b32 v249, v251
    buffer_store_dwordx4 v[248:251], v4, s[16:19], s28 offen offset:0
    v_permlane16_swap_b32 v252, v254
    v_permlane16_swap_b32 v253, v255
    buffer_store_dwordx4 v[252:255], v4, s[16:19], s28 offen offset:32
    s_or_b32 s27, s2, s22
    s_cmp_lg_u32 s27, 0
    s_cbranch_scc1 L_end
    s_add_u32 s27, s79, 32
    v_mov_b32 v4, 0
    v_mov_b32 v5, s27
    s_mov_b64 exec, 1
    buffer_store_dword v5, v4, s[8:11], 0 offen
L_end:
    s_endpgm
L_qp_hook:
    s_sub_u32 s27, s41, s46
    s_cmp_eq_u32 s27, 1
    s_cbranch_scc1 L_qp_s1
    s_cmp_eq_u32 s27, 2
    s_cbranch_scc1 L_qp_s2
    s_cmp_eq_u32 s27, 3
    s_cbranch_scc1 L_qp_s3
    s_cmp_eq_u32 s27, 4
    s_cbranch_scc1 L_qp_s4
    s_cmp_eq_u32 s27, 5
    s_cbranch_scc1 L_qp_s5
    s_lshl_b32 s27, s26, 13
    s_add_u32 s27, s27, 65536
    s_mul_i32 s28, s41, 24576
    s_add_u32 s27, s27, s28
    v_xor_b32 v5, 32, v233
    v_add_u32 v7, s27, v233
    v_add_u32 v6, s27, v5
    ds_read_b128 v[32:35], v7 offset:0
    ds_read_b128 v[36:39], v6 offset:1024
    ds_read_b128 v[40:43], v7 offset:2048
    ds_read_b128 v[44:47], v6 offset:3072
    ds_read_b128 v[48:51], v7 offset:4096
    ds_read_b128 v[52:55], v6 offset:5120
    ds_read_b128 v[56:59], v7 offset:6144
    ds_read_b128 v[60:63], v6 offset:7168
    v_mov_b32 v8, 0x3f80
    v_mov_b32 v9, 0x3f800000
    v_mov_b32 v24, 0
    v_mov_b32 v25, 0
    v_mov_b32 v26, 0
    v_mov_b32 v27, 0
    v_mov_b32 v28, 0
    v_mov_b32 v29, 0
    v_mov_b32 v30, 0
    v_mov_b32 v31, 0
    s_waitcnt lgkmcnt(0)
    s_cmp_eq_u32 s74, 0
    s_cbranch_scc1 L_qp_ret
    s_lshl_b32 s27, s26, 1
    s_lshr_b32 s28, s21, 3
    s_add_u32 s27, s27, s28
    s_lshl_b32 s27, s27, 17
    s_lshl_b32 s28, s20, 13
    s_add_u32 s27, s27, s28
    s_add_u32 s28, s27, 4096
    buffer_store_dwordx4 v[32:35], v233, s[72:75], s27 offen offset:0 sc1
    buffer_store_dwordx4 v[36:39], v5, s[72:75], s27 offen offset:1024 sc1
    buffer_store_dwordx4 v[40:43], v233, s[72:75], s27 offen offset:2048 sc1
    buffer_store_dwordx4 v[44:47], v5, s[72:75], s27 offen offset:3072 sc1
    buffer_store_dwordx4 v[48:51], v233, s[72:75], s28 offen offset:0 sc1
    buffer_store_dwordx4 v[52:55], v5, s[72:75], s28 offen offset:1024 sc1
    buffer_store_dwordx4 v[56:59], v233, s[72:75], s28 offen offset:2048 sc1
    buffer_store_dwordx4 v[60:63], v5, s[72:75], s28 offen offset:3072 sc1
    s_add_u32 s41, s41, 1
    s_waitcnt vmcnt(22)
    s_branch L_qp_bar
L_qp_s1:
    v_dot2_f32_bf16 v24, v32, v8, v24
    v_dot2_f32_bf16 v25, v32, v9, v25
    v_dot2_f32_bf16 v26, v33, v8, v26
    v_dot2_f32_bf16 v27, v33, v9, v27
    v_dot2_f32_bf16 v28, v34, v8, v28
    v_dot2_f32_bf16 v29, v34, v9, v29
    v_dot2_f32_bf16 v30, v35, v8, v30
    v_dot2_f32_bf16 v31, v35, v9, v31
    v_dot2_f32_bf16 v24, v36, v8, v24
    v_dot2_f32_bf16 v25, v36, v9, v25
    v_dot2_f32_bf16 v26, v37, v8, v26
    v_dot2_f32_bf16 v27, v37, v9, v27
    v_dot2_f32_bf16 v28, v38, v8, v28
    v_dot2_f32_bf16 v29, v38, v9, v29
    v_dot2_f32_bf16 v30, v39, v8, v30
    v_dot2_f32_bf16 v31, v39, v9, v31
    s_branch L_qp_ret
L_qp_s2:
    v_dot2_f32_bf16 v24, v40, v8, v24
    v_dot2_f32_bf16 v25, v40, v9, v25
    v_dot2_f32_bf16 v26, v41, v8, v26
    v_dot2_f32_bf16 v27, v41, v9, v27
    v_dot2_f32_bf16 v28, v42, v8, v28
    v_dot2_f32_bf16 v29, v42, v9, v29
    v_dot2_f32_bf16 v30, v43, v8, v30
    v_dot2_f32_bf16 v31, v43, v9, v31
    v_dot2_f32_bf16 v24, v44, v8, v24
    v_dot2_f32_bf16 v25, v44, v9, v25
    v_dot2_f32_bf16 v26, v45, v8, v26
    v_dot2_f32_bf16 v27, v45, v9, v27
    v_dot2_f32_bf16 v28, v46, v8, v28
    v_dot2_f32_bf16 v29, v46, v9, v29
    v_dot2_f32_bf16 v30, v47, v8, v30
    v_dot2_f32_bf16 v31, v47, v9, v31
    s_branch L_qp_ret
L_qp_s3:
    v_dot2_f32_bf16 v24, v48, v8, v24
    v_dot2_f32_bf16 v25, v48, v9, v25
    v_dot2_f32_bf16 v26, v49, v8, v26
    v_dot2_f32_bf16 v27, v49, v9, v27
    v_dot2_f32_bf16 v28, v50, v8, v28
    v_dot2_f32_bf16 v29, v50, v9, v29
    v_dot2_f32_bf16 v30, v51, v8, v30
    v_dot2_f32_bf16 v31, v51, v9, v31
    v_dot2_f32_bf16 v24, v52, v8, v24
    v_dot2_f32_bf16 v25, v52, v9, v25
    v_dot2_f32_bf16 v26, v53, v8, v26
    v_dot2_f32_bf16 v27, v53, v9, v27
    v_dot2_f32_bf16 v28, v54, v8, v28
    v_dot2_f32_bf16 v29, v54, v9, v29
    v_dot2_f32_bf16 v30, v55, v8, v30
    v_dot2_f32_bf16 v31, v55, v9, v31
    s_branch L_qp_ret
L_qp_s4:
    v_dot2_f32_bf16 v24, v56, v8, v24
    v_dot2_f32_bf16 v25, v56, v9, v25
    v_dot2_f32_bf16 v26, v57, v8, v26
    v_dot2_f32_bf16 v27, v57, v9, v27
    v_dot2_f32_bf16 v28, v58, v8, v28
    v_dot2_f32_bf16 v29, v58, v9, v29
    v_dot2_f32_bf16 v30, v59, v8, v30
    v_dot2_f32_bf16 v31, v59, v9, v31
    v_dot2_f32_bf16 v24, v60, v8, v24
    v_dot2_f32_bf16 v25, v60, v9, v25
    v_dot2_f32_bf16 v26, v61, v8, v26
    v_dot2_f32_bf16 v27, v61, v9, v27
    v_dot2_f32_bf16 v28, v62, v8, v28
    v_dot2_f32_bf16 v29, v62, v9, v29
    v_dot2_f32_bf16 v30, v63, v8, v30
    v_dot2_f32_bf16 v31, v63, v9, v31
    s_branch L_qp_ret
L_qp_s5:
    v_permlane32_swap_b32 v24, v28
    v_permlane32_swap_b32 v25, v29
    v_permlane32_swap_b32 v26, v30
    v_permlane32_swap_b32 v27, v31
    v_add_f32 v24, v24, v28
    v_add_f32 v25, v25, v29
    v_add_f32 v26, v26, v30
    v_add_f32 v27, v27, v31
    s_nop 1
    v_permlane16_swap_b32 v24, v26
    v_permlane16_swap_b32 v25, v27
    v_add_f32 v24, v24, v26
    v_add_f32 v25, v25, v27
    v_and_b32 v7, 8, v1
    v_cmp_ne_u32 vcc, 0, v7
    v_add_f32_dpp v26, v24, v24 row_ror:8 row_mask:0xf bank_mask:0xf
    v_add_f32_dpp v27, v25, v25 row_ror:8 row_mask:0xf bank_mask:0xf
    v_mov_b32 v25, s78
    v_cndmask_b32 v24, v26, v27, vcc
    v_lshlrev_b32 v7, 3, v1
    s_lshl_b32 s27, s21, 15
    s_lshl_b32 s28, s26, 13
    s_add_u32 s27, s27, s28
    s_lshl_b32 s28, s20, 9
    s_add_u32 s27, s27, s28
    s_add_u32 s27, s27, 0x1800000
    buffer_store_dwordx2 v[24:25], v7, s[8:11], s27 offen sc1
    s_branch L_qp_ret
L_at_hookD:
    s_cmp_lg_u32 s34, 1
    s_cbranch_scc1 L_hk_62
    s_waitcnt vmcnt(8)
    s_barrier
    v_and_b32 v56, 15, v1
    v_lshlrev_b32 v56, 4, v56
    v_bfe_u32 v57, v1, 4, 1
    v_mul_u32_u24 v57, 1024, v57
    v_add_u32 v56, v56, v57
    buffer_load_dword v150, v56, s[8:11], s44 offen sc1
    s_branch L_at_retD
L_hk_62:
    s_cmp_lg_u32 s34, 2
    s_cbranch_scc1 L_hk_63
    s_waitcnt vmcnt(8)
    s_barrier
    v_cmp_ne_u32 vcc, s78, v150
    s_cbranch_vccz L_at_retD
    v_and_b32 v56, 15, v1
    v_lshlrev_b32 v56, 4, v56
    v_bfe_u32 v57, v1, 4, 1
    v_mul_u32_u24 v57, 1024, v57
    v_add_u32 v56, v56, v57
    s_mov_b32 s27, 0
L_poll_64:
    buffer_load_dword v57, v56, s[8:11], s44 offen sc1
    s_add_u32 s27, s27, 1
    s_waitcnt vmcnt(0)
    v_cmp_ne_u32 vcc, s78, v57
    s_cbranch_vccz L_pd_65
    s_sleep 1
    s_cmp_lt_u32 s27, 0x40000
    s_cbranch_scc1 L_poll_64
L_pd_65:
    s_branch L_at_retD
L_hk_63:
    s_cmp_lg_u32 s34, 13
    s_cbranch_scc1 L_hk_66
    s_waitcnt vmcnt(8)
    s_barrier
    v_and_b32 v56, 15, v1
    v_lshlrev_b32 v56, 4, v56
    s_lshl_b32 s25, s21, 9
    s_add_u32 s25, s25, 0x1ac0000
    buffer_load_dword v150, v56, s[8:11], s25 offen sc1
    s_branch L_at_retD
L_hk_66:
    s_waitcnt vmcnt(8)
    s_barrier
    s_cmp_eq_u32 s23, 1
    s_cbranch_scc1 L_at_wpre
    v_cmp_ne_u32 vcc, s78, v150
    s_cbranch_vccz L_at_wpre
    v_and_b32 v56, 15, v1
    v_lshlrev_b32 v56, 4, v56
    s_mov_b32 s27, 0
L_poll_68:
    buffer_load_dword v57, v56, s[8:11], s25 offen sc1
    s_add_u32 s27, s27, 1
    s_waitcnt vmcnt(0)
    v_cmp_ne_u32 vcc, s78, v57
    s_cbranch_vccz L_pd_69
    s_sleep 1
    s_cmp_lt_u32 s27, 0x40000
    s_cbranch_scc1 L_poll_68
L_pd_69:
L_at_wpre:
    v_lshrrev_b32 v56, 3, v1
    v_lshlrev_b32 v56, 11, v56
    v_and_b32 v57, 0x70, v233
    v_add_u32 v56, v56, v57
    v_xor_b32 v57, 32, v56
    s_and_b32 s29, s46, 2
    s_add_u32 s29, s29, s46
    s_mov_b32 s15, 0x20000
    s_and_b32 s27, s21, 7
    s_cmp_eq_u32 s27, 3
    s_cbranch_scc1 L_wl_70
    s_mov_b32 s12, s82
    s_mov_b32 s13, s83
    s_mov_b32 s14, 0x200000
    s_mov_b32 s44, 16
    s_lshl_b32 s27, s29, 15
    s_lshl_b32 s28, s21, 7
    s_add_u32 s27, s27, s28
    s_add_u32 s28, s27, 15360
    v_add_u32 v193, s27, v56
    v_add_u32 v194, s28, v57
    s_branch L_wd_71
L_wl_70:
    s_add_u32 s12, s4, 0x1d00000
    s_addc_u32 s13, s5, 0
    s_mov_b32 s14, 0x100000
    s_mov_b32 s44, 12
    s_lshr_b32 s27, s21, 3
    s_mul_i32 s27, s27, 131072
    s_lshl_b32 s28, s29, 11
    s_add_u32 s27, s27, s28
    v_add_u32 v193, s27, v2
    v_mov_b32 v194, v193
L_wd_71:
    s_lshl_b32 s29, s46, 11
    s_mov_b32 s28, 1
    s_add_u32 m0, s29, 131072
    s_lshl_b32 s27, s28, s44
    buffer_load_dwordx4 v193, s[12:15], s27 offen sc1 lds
    buffer_load_dwordx4 v194, s[12:15], s27 offen offset:1024 sc1 lds
    s_mov_b32 s28, 5
    s_add_u32 m0, s29, 139264
    s_lshl_b32 s27, s28, s44
    buffer_load_dwordx4 v193, s[12:15], s27 offen sc1 lds
    buffer_load_dwordx4 v194, s[12:15], s27 offen offset:1024 sc1 lds
    s_mov_b32 s28, 9
    s_add_u32 m0, s29, 147456
    s_lshl_b32 s27, s28, s44
    buffer_load_dwordx4 v193, s[12:15], s27 offen sc1 lds
    buffer_load_dwordx4 v194, s[12:15], s27 offen offset:1024 sc1 lds
    s_branch L_at_retD
L_at_hookS:
    s_cmp_eq_u32 s34, 2
    s_cbranch_scc1 L_hs2
    s_cmp_eq_u32 s34, 3
    s_cbranch_scc1 L_hs3
    s_cmp_eq_u32 s34, 4
    s_cbranch_scc1 L_hs4
    s_cmp_eq_u32 s34, 5
    s_cbranch_scc1 L_hs5
    s_cmp_eq_u32 s34, 6
    s_cbranch_scc1 L_hs6
    s_cmp_eq_u32 s34, 7
    s_cbranch_scc1 L_hs7
    s_cmp_eq_u32 s34, 8
    s_cbranch_scc1 L_hs8
    s_cmp_eq_u32 s34, 9
    s_cbranch_scc1 L_hs9
    s_cmp_eq_u32 s34, 10
    s_cbranch_scc1 L_hs10
    s_cmp_eq_u32 s34, 11
    s_cbranch_scc1 L_hs11
    s_cmp_eq_u32 s34, 12
    s_cbranch_scc1 L_hs12
    s_cmp_eq_u32 s34, 13
    s_cbranch_scc1 L_hs13
L_hs1:
    v_mov_b32 v196, 0x3f80
    v_mov_b32 v197, 0x3f800000
    v_mov_b32 v188, 0
    v_mov_b32 v189, 0
    v_mov_b32 v190, 0
    v_mov_b32 v191, 0
    v_mov_b32 v192, 0
    v_mov_b32 v193, 0
    v_mov_b32 v194, 0
    v_mov_b32 v195, 0
    s_waitcnt vmcnt(0)
    v_dot2_f32_bf16 v188, v152, v196, v188
    v_dot2_f32_bf16 v189, v152, v197, v189
    v_dot2_f32_bf16 v190, v153, v196, v190
    v_dot2_f32_bf16 v191, v153, v197, v191
    v_dot2_f32_bf16 v192, v154, v196, v192
    v_dot2_f32_bf16 v193, v154, v197, v193
    v_dot2_f32_bf16 v194, v155, v196, v194
    v_dot2_f32_bf16 v195, v155, v197, v195
    v_dot2_f32_bf16 v188, v156, v196, v188
    v_dot2_f32_bf16 v189, v156, v197, v189
    v_dot2_f32_bf16 v190, v157, v196, v190
    v_dot2_f32_bf16 v191, v157, v197, v191
    v_dot2_f32_bf16 v192, v158, v196, v192
    v_dot2_f32_bf16 v193, v158, v197, v193
    v_dot2_f32_bf16 v194, v159, v196, v194
    v_dot2_f32_bf16 v195, v159, v197, v195
    v_dot2_f32_bf16 v188, v160, v196, v188
    v_dot2_f32_bf16 v189, v160, v197, v189
    v_dot2_f32_bf16 v190, v161, v196, v190
    v_dot2_f32_bf16 v191, v161, v197, v191
    v_dot2_f32_bf16 v192, v162, v196, v192
    v_dot2_f32_bf16 v193, v162, v197, v193
    v_dot2_f32_bf16 v194, v163, v196, v194
    v_dot2_f32_bf16 v195, v163, v197, v195
    v_dot2_f32_bf16 v188, v164, v196, v188
    v_dot2_f32_bf16 v189, v164, v197, v189
    v_dot2_f32_bf16 v190, v165, v196, v190
    v_dot2_f32_bf16 v191, v165, v197, v191
    v_dot2_f32_bf16 v192, v166, v196, v192
    v_dot2_f32_bf16 v193, v166, v197, v193
    v_dot2_f32_bf16 v194, v167, v196, v194
    v_dot2_f32_bf16 v195, v167, v197, v195
    v_dot2_f32_bf16 v188, v168, v196, v188
    v_dot2_f32_bf16 v189, v168, v197, v189
    v_dot2_f32_bf16 v190, v169, v196, v190
    v_dot2_f32_bf16 v191, v169, v197, v191
    v_dot2_f32_bf16 v192, v170, v196, v192
    v_dot2_f32_bf16 v193, v170, v197, v193
    v_dot2_f32_bf16 v194, v171, v196, v194
    v_dot2_f32_bf16 v195, v171, v197, v195
    v_dot2_f32_bf16 v188, v172, v196, v188
    v_dot2_f32_bf16 v189, v172, v197, v189
    v_dot2_f32_bf16 v190, v173, v196, v190
    v_dot2_f32_bf16 v191, v173, v197, v191
    v_dot2_f32_bf16 v192, v174, v196, v192
    v_dot2_f32_bf16 v193, v174, v197, v193
    v_dot2_f32_bf16 v194, v175, v196, v194
    v_dot2_f32_bf16 v195, v175, v197, v195
    v_dot2_f32_bf16 v188, v176, v196, v188
    v_dot2_f32_bf16 v189, v176, v197, v189
    v_dot2_f32_bf16 v190, v177, v196, v190
    v_dot2_f32_bf16 v191, v177, v197, v191
    v_dot2_f32_bf16 v192, v178, v196, v192
    v_dot2_f32_bf16 v193, v178, v197, v193
    v_dot2_f32_bf16 v194, v179, v196, v194
    v_dot2_f32_bf16 v195, v179, v197, v195
    v_dot2_f32_bf16 v188, v180, v196, v188
    v_dot2_f32_bf16 v189, v180, v197, v189
    v_dot2_f32_bf16 v190, v181, v196, v190
    v_dot2_f32_bf16 v191, v181, v197, v191
    v_dot2_f32_bf16 v192, v182, v196, v192
    v_dot2_f32_bf16 v193, v182, v197, v193
    v_dot2_f32_bf16 v194, v183, v196, v194
    v_dot2_f32_bf16 v195, v183, v197, v195
    s_nop 3
    v_permlane32_swap_b32 v188, v192
    v_permlane32_swap_b32 v189, v193
    v_permlane32_swap_b32 v190, v194
    v_permlane32_swap_b32 v191, v195
    v_add_f32 v188, v188, v192
    v_add_f32 v189, v189, v193
    v_add_f32 v190, v190, v194
    v_add_f32 v191, v191, v195
    s_nop 1
    v_permlane16_swap_b32 v188, v190
    v_permlane16_swap_b32 v189, v191
    v_add_f32 v188, v188, v190
    v_add_f32 v189, v189, v191
    v_and_b32 v56, 8, v1
    v_cmp_ne_u32 vcc, 0, v56
    v_add_f32_dpp v190, v188, v188 row_ror:8 row_mask:0xf bank_mask:0xf
    v_add_f32_dpp v191, v189, v189 row_ror:8 row_mask:0xf bank_mask:0xf
    v_mov_b32 v189, s78
    v_cndmask_b32 v188, v190, v191, vcc
    v_lshlrev_b32 v56, 3, v1
    s_lshl_b32 s27, s21, 15
    s_lshl_b32 s28, s22, 13
    s_add_u32 s27, s27, s28
    s_lshl_b32 s28, s20, 9
    s_add_u32 s27, s27, s28
    s_add_u32 s27, s27, 0x1880000
    buffer_store_dwordx2 v[188:189], v56, s[8:11], s27 offen sc1
    s_add_u32 s27, s41, 0x0
    buffer_load_dwordx4 v[152:155], v232, s[64:67], s27 offen
    s_branch L_at_retS
L_hs2:
    s_add_u32 s27, s41, 0x10000
    buffer_load_dwordx4 v[156:159], v232, s[64:67], s27 offen
    s_branch L_at_retS
L_hs3:
    s_add_u32 s27, s42, 0x0
    buffer_load_dwordx4 v[160:163], v232, s[68:71], s27 offen
    s_branch L_at_retS
L_hs4:
    s_add_u32 s27, s42, 0x10000
    buffer_load_dwordx4 v[164:167], v232, s[68:71], s27 offen
    s_branch L_at_retS
L_hs5:
    s_waitcnt vmcnt(3)
    s_add_u32 s27, s43, 0x0
    buffer_store_dwordx4 v[152:155], v234, s[72:75], s27 offen sc1
    s_add_u32 s27, s42, 0x20000
    buffer_load_dwordx4 v[168:171], v232, s[68:71], s27 offen
    s_branch L_at_retS
L_hs6:
    s_waitcnt vmcnt(4)
    s_add_u32 s27, s43, 0x1000
    buffer_store_dwordx4 v[156:159], v234, s[72:75], s27 offen sc1
    s_branch L_at_retS
L_hs7:
    s_waitcnt vmcnt(0)
    s_waitcnt vmcnt(4)
    s_add_u32 s27, s44, 0x0
    buffer_store_dwordx4 v[160:163], v234, s[72:75], s27 offen sc1
    s_branch L_at_retS
L_hs8:
    s_cmp_lg_u32 s22, 0
    s_cbranch_scc1 L_fw_72
    s_lshl_b32 s27, s21, 9
    s_lshl_b32 s28, s20, 4
    s_add_u32 s27, s27, s28
    s_add_u32 s27, s27, 0x1ac0000
    v_mov_b32 v56, 0
    v_mov_b32 v57, s78
    s_waitcnt vmcnt(63)
    s_mov_b64 exec, 1
    buffer_store_dword v57, v56, s[8:11], s27 offen sc1
    s_mov_b64 exec, -1
L_fw_72:
    s_waitcnt vmcnt(4)
    s_add_u32 s27, s44, 0x1000
    buffer_store_dwordx4 v[164:167], v234, s[72:75], s27 offen sc1
    s_add_u32 s27, s42, 0x30000
    buffer_load_dwordx4 v[172:175], v232, s[68:71], s27 offen
    s_add_u32 s27, s42, 0x40000
    buffer_load_dwordx4 v[176:179], v232, s[68:71], s27 offen
    s_branch L_at_retS
L_hs9:
    s_waitcnt vmcnt(5)
    s_add_u32 s27, s44, 0x2000
    buffer_store_dwordx4 v[168:171], v234, s[72:75], s27 offen sc1
    s_add_u32 s27, s42, 0x50000
    buffer_load_dwordx4 v[180:183], v232, s[68:71], s27 offen
    s_add_u32 s27, s42, 0x60000
    buffer_load_dwordx4 v[184:187], v232, s[68:71], s27 offen
    s_branch L_at_retS
L_hs10:
    s_branch L_at_retS
L_hs11:
    s_branch L_at_retS
L_hs12:
    s_waitcnt vmcnt(4)
    s_add_u32 s27, s44, 0x3000
    buffer_store_dwordx4 v[172:175], v234, s[72:75], s27 offen sc1
    s_waitcnt vmcnt(4)
    s_add_u32 s27, s44, 0x4000
    buffer_store_dwordx4 v[176:179], v234, s[72:75], s27 offen sc1
    s_branch L_at_retS
L_hs13:
    s_waitcnt vmcnt(3)
    s_add_u32 s27, s44, 0x5000
    buffer_store_dwordx4 v[180:183], v234, s[72:75], s27 offen sc1
    s_waitcnt vmcnt(3)
    s_add_u32 s27, s44, 0x6000
    buffer_store_dwordx4 v[184:187], v234, s[72:75], s27 offen sc1
    s_branch L_at_retS
L_at_slow:
    v_mov_b32 v32, 0
    v_mov_b32 v33, 0
    v_mov_b32 v34, 0
    v_mov_b32 v35, 0
    v_mov_b32 v36, 0
    v_mov_b32 v37, 0
    v_mov_b32 v38, 0
    v_mov_b32 v39, 0
    v_mov_b32 v40, 0
    v_mov_b32 v41, 0
    v_mov_b32 v42, 0
    v_mov_b32 v43, 0
    v_mov_b32 v44, 0
    v_mov_b32 v45, 0
    v_mov_b32 v46, 0
    v_mov_b32 v47, 0
    v_mov_b32 v12, 0
    v_mov_b32 v13, 0
    v_mov_b32 v14, 0
    v_mov_b32 v15, 0
    v_mov_b32 v58, 0xff800000
    s_lshl_b32 s32, s51, 11
    s_lshl_b32 s27, s45, 12
    s_add_u32 s32, s32, s27
    s_add_u32 s32, s32, 0x100000
    s_mov_b32 s34, 0
    s_lshl_b32 s29, s47, 1
    s_add_u32 s29, s29, 0
    s_lshl_b32 s25, s29, 9
    s_add_u32 s25, s25, 0x1900000
    v_and_b32 v56, 15, v1
    v_lshlrev_b32 v56, 4, v56
    s_mov_b32 s27, 0
L_poll_73:
    buffer_load_dword v57, v56, s[8:11], s25 offen sc1
    s_add_u32 s27, s27, 1
    s_waitcnt vmcnt(0)
    v_cmp_ne_u32 vcc, s78, v57
    s_cbranch_vccz L_pd_74
    s_sleep 1
    s_cmp_lt_u32 s27, 0x40000
    s_cbranch_scc1 L_poll_73
L_pd_74:
    s_lshl_b32 s29, s47, 1
    s_add_u32 s29, s29, 1
    s_lshl_b32 s25, s29, 9
    s_add_u32 s25, s25, 0x1900000
    v_and_b32 v56, 15, v1
    v_lshlrev_b32 v56, 4, v56
    s_mov_b32 s27, 0
L_poll_75:
    buffer_load_dword v57, v56, s[8:11], s25 offen sc1
    s_add_u32 s27, s27, 1
    s_waitcnt vmcnt(0)
    v_cmp_ne_u32 vcc, s78, v57
    s_cbranch_vccz L_pd_76
    s_sleep 1
    s_cmp_lt_u32 s27, 0x40000
    s_cbranch_scc1 L_poll_75
L_pd_76:
L_at_sl:
    buffer_load_dwordx4 v[112:115], v2, s[8:11], s32 offen offset:0 sc1
    buffer_load_dwordx4 v[116:119], v2, s[8:11], s32 offen offset:1024 sc1
    buffer_load_dwordx4 v[128:131], v2, s[8:11], s32 offen offset:2048 sc1
    buffer_load_dwordx4 v[132:135], v2, s[8:11], s32 offen offset:3072 sc1
    s_waitcnt vmcnt(0)
    v_mfma_f32_32x32x16_bf16 v[64:79], v[112:115], v[4:7], 0
    v_mfma_f32_32x32x16_bf16 v[64:79], v[116:119], v[8:11], v[64:79]
    s_nop 15
    v_max3_f32 v56, v64, v65, v66
    v_max3_f32 v56, v56, v67, v68
    v_max3_f32 v56, v56, v69, v70
    v_max3_f32 v56, v56, v71, v72
    v_max3_f32 v56, v56, v73, v74
    v_max3_f32 v56, v56, v75, v76
    v_max3_f32 v56, v56, v77, v78
    v_max3_f32 v56, v56, v79, v58
    v_mov_b32 v57, v56
    s_nop 1
    v_permlane32_swap_b32 v56, v57
    v_max_f32 v56, v56, v57
    v_sub_f32 v57, v58, v56
    v_exp_f32 v57, v57
    v_mov_b32 v58, v56
    v_sub_f32 v64, v64, v56
    v_sub_f32 v65, v65, v56
    v_sub_f32 v66, v66, v56
    v_sub_f32 v67, v67, v56
    v_sub_f32 v68, v68, v56
    v_sub_f32 v69, v69, v56
    v_sub_f32 v70, v70, v56
    v_sub_f32 v71, v71, v56
    v_sub_f32 v72, v72, v56
    v_sub_f32 v73, v73, v56
    v_sub_f32 v74, v74, v56
    v_sub_f32 v75, v75, v56
    v_sub_f32 v76, v76, v56
    v_sub_f32 v77, v77, v56
    v_sub_f32 v78, v78, v56
    v_sub_f32 v79, v79, v56
    v_exp_f32 v64, v64
    v_exp_f32 v65, v65
    v_exp_f32 v66, v66
    v_exp_f32 v67, v67
    v_exp_f32 v68, v68
    v_exp_f32 v69, v69
    v_exp_f32 v70, v70
    v_exp_f32 v71, v71
    v_exp_f32 v72, v72
    v_exp_f32 v73, v73
    v_exp_f32 v74, v74
    v_exp_f32 v75, v75
    v_exp_f32 v76, v76
    v_exp_f32 v77, v77
    v_exp_f32 v78, v78
    v_exp_f32 v79, v79
    v_mul_f32 v32, v57, v32
    v_mul_f32 v33, v57, v33
    v_mul_f32 v34, v57, v34
    v_mul_f32 v35, v57, v35
    v_mul_f32 v36, v57, v36
    v_mul_f32 v37, v57, v37
    v_mul_f32 v38, v57, v38
    v_mul_f32 v39, v57, v39
    v_mul_f32 v40, v57, v40
    v_mul_f32 v41, v57, v41
    v_mul_f32 v42, v57, v42
    v_mul_f32 v43, v57, v43
    v_mul_f32 v44, v57, v44
    v_mul_f32 v45, v57, v45
    v_mul_f32 v46, v57, v46
    v_mul_f32 v47, v57, v47
    v_mul_f32 v12, v57, v12
    v_mul_f32 v13, v57, v13
    v_mul_f32 v14, v57, v14
    v_mul_f32 v15, v57, v15
    v_cvt_pk_bf16_f32 v96, v64, v65
    v_cvt_pk_bf16_f32 v97, v66, v67
    v_cvt_pk_bf16_f32 v98, v68, v69
    v_cvt_pk_bf16_f32 v99, v70, v71
    v_cvt_pk_bf16_f32 v100, v72, v73
    v_cvt_pk_bf16_f32 v101, v74, v75
    v_cvt_pk_bf16_f32 v102, v76, v77
    v_cvt_pk_bf16_f32 v103, v78, v79
    s_nop 1
    v_mfma_f32_32x32x16_bf16 v[32:47], v[128:131], v[96:99], v[32:47]
    v_mfma_f32_32x32x16_bf16 v[32:47], v[132:135], v[100:103], v[32:47]
    v_smfmac_f32_16x16x64_bf16 v[12:15], v[48:51], v[96:103], v52
    s_nop 15
    s_add_u32 s32, s32, 229376
    s_add_u32 s34, s34, 1
    s_cmp_lt_u32 s34, 64
    s_cbranch_scc1 L_at_sl
    v_add_f32 v12, v12, v13
    s_branch L_at_fin
L_f2_plast:
    s_waitcnt vmcnt(6)
    s_barrier
    s_waitcnt vmcnt(0)
    s_barrier
    s_barrier
    s_endpgm
L_code_end:
.section .rodata,"a"
.p2align 6
.amdhsa_kernel interleave_layers__softmax_full_mha__dense_activation_relu__prompt_kernel
  .amdhsa_next_free_vgpr 256
  .amdhsa_next_free_sgpr 102
  .amdhsa_accum_offset 256
  .amdhsa_group_segment_fixed_size 0
  .amdhsa_kernarg_size 72
  .amdhsa_user_sgpr_count 2
  .amdhsa_user_sgpr_kernarg_segment_ptr 1
  .amdhsa_system_sgpr_workgroup_id_x 1
.end_amdhsa_kernel
```
